```python
import torch

def _softmax(x, axis=-1):
    return torch.softmax(x, dim=axis)
def _gelu(x):
    return torch.nn.functional.gelu(x, approximate="tanh")
def _silu(x):
    return torch.nn.functional.silu(x)
def _sigmoid(x):
    return torch.sigmoid(x)
def _layernorm(x, axis=-1, eps=1e-5):
    m = x.mean(dim=axis, keepdim=True)
    v = x.var(dim=axis, keepdim=True, unbiased=False)
    return (x - m) / torch.sqrt(v + eps)
def _scatter_add(tgt, idx, src, axis=0):
    return tgt.clone().index_add_(axis, idx, src)
def _segment_sum(src, seg, n):
    out = torch.zeros((n,) + src.shape[1:], dtype=src.dtype)
    return out.index_add_(0, seg, src)
def _pad(x, pw):
    flat = tuple(v for pair in reversed(pw) for v in pair)
    return torch.nn.functional.pad(x, flat)

kernel_name = 'concat_heads__mha_block__spectral_gfnet__prompt'

def setup_inputs():

    _w = (lambda a: (lambda t: t.to(torch.bfloat16) if t.is_floating_point() else t)(torch.as_tensor(a)))
    def _A_setup():
        B, S, D, H = 1, 2048, 512, 32
        return {
            "x": _w((lambda *s: torch.randn(*s, dtype=torch.bfloat16) * 0.2)(B, S, D)),
            "wqkv": _w((lambda *s: torch.randn(*s, dtype=torch.bfloat16) * 0.2)(D, 3 * D)),
            "wo": _w((lambda *s: torch.randn(*s, dtype=torch.bfloat16) * 0.05)(D, D)),
        }
    _A_in = _A_setup()

    def _B_setup():
        B, S, D = 1, 2048, 512
        Df = D // 2 + 1
        return {
            "x": _w((lambda *s: torch.randn(*s, dtype=torch.bfloat16) * 0.05)(B, S, D)),
            "w_r": _w((lambda *s: torch.randn(*s, dtype=torch.bfloat16) * 6.4)(S, Df) * 0.02),
            "w_i": _w((lambda *s: torch.randn(*s, dtype=torch.bfloat16) * 6.4)(S, Df) * 0.02),
        }
    _B_in = _B_setup()

    return {
        "A_x": _A_in["x"],
        "A_wqkv": _A_in["wqkv"],
        "A_wo": _A_in["wo"],
        "B_x": _B_in["x"],
        "B_w_r": _B_in["w_r"],
        "B_w_i": _B_in["w_i"],
    }

def reference(A_x, A_wqkv, A_wo, B_x, B_w_r, B_w_i):
    def _A_ref(x, wqkv, wo):
        B, S, D = x.shape
        H = 32
        Dh = D // H
        qkv = (lambda x, *d: x.permute(*d))((x @ wqkv).reshape(B, S, 3, H, Dh), 2, 0, 3, 1, 4)
        q, k, v = qkv[0], qkv[1], qkv[2]
        scores = torch.einsum("bhqd,bhkd->bhqk", q, k) * (Dh ** -0.5)
        p = _softmax(scores, axis=-1)
        o = torch.einsum("bhqk,bhkd->bhqd", p, v)
        return (lambda x, *d: x.permute(*d))(o, 0, 2, 1, 3).reshape(B, S, D) @ wo

    def _B_ref(x, w_r, w_i):
        B, S, D = x.shape
        X = (lambda x, axes=(-2,-1): torch.fft.rfft2(x.float(), dim=axes))(x, axes=(-2, -1))
        W = w_r + 1j * w_i
        X = X * W
        y = (lambda x, s, axes=(-2,-1): torch.fft.irfft2(x, s=s, dim=axes).to(torch.bfloat16))(X, (S, D), axes=(-2, -1))
        return y

    a = _A_ref(A_x, A_wqkv, A_wo)
    b = _B_ref(B_x, B_w_r, B_w_i)
    return torch.concatenate([a, b], axis=-1)
```

```asm
; @launch grid=(256,1,1) block=(768,1,1) lds=160256
.amdgcn_target "amdgcn-amd-amdhsa--gfx950"
.text
.globl concat_heads__mha_block__spectral_gfnet__prompt_kernel
.p2align 8
.type concat_heads__mha_block__spectral_gfnet__prompt_kernel,@function
concat_heads__mha_block__spectral_gfnet__prompt_kernel:
  s_cmp_ge_u32 s2, 256
  s_cbranch_scc1 L_end
  s_load_dwordx16 s[48:63], s[0:1], 0
  s_load_dwordx2 s[64:65], s[0:1], 64
  v_lshrrev_b32 v2, 6, v0
  v_and_b32 v3, 63, v0
  v_lshlrev_b32 v1, 4, v3
  v_readfirstlane_b32 s40, v2
  s_mov_b32 s71, 0
  s_mov_b32 s45, 0
  s_lshr_b32 s43, s2, 3
  s_and_b32 s44, s2, 7
  s_and_b32 s41, s40, 3
  v_and_b32 v2, 3, v2
  s_cmp_ge_u32 s40, 8
  s_cbranch_scc1 L_B_p1
  s_waitcnt lgkmcnt(0)
  s_mov_b32 s4, s48
  s_mov_b32 s5, s49
  s_mov_b32 s6, 2097152
  s_mov_b32 s7, 0x20000
  s_mov_b32 s8, s50
  s_mov_b32 s9, s51
  s_mov_b32 s10, 1572864
  s_mov_b32 s11, 0x20000
  s_mov_b32 s12, s54
  s_mov_b32 s13, s55
  s_mov_b32 s14, 2097152
  s_mov_b32 s15, 0x20000
  s_cmp_lt_u32 s41, 2
  s_cselect_b32 s16, s56, s58
  s_cselect_b32 s17, s57, s59
  s_mov_b32 s18, 1052672
  s_mov_b32 s19, 0x20000
  s_mov_b32 s20, s64
  s_mov_b32 s21, s65
  s_mov_b32 s22, 18350080
  s_mov_b32 s23, 0x20000
  s_mov_b32 s28, s52
  s_mov_b32 s29, s53
  s_mov_b32 s30, 524288
  s_mov_b32 s31, 0x20000
  s_mov_b32 s32, s60
  s_mov_b32 s33, s61
  s_mov_b32 s34, 4194304
  s_mov_b32 s35, 0x20000
  s_mov_b32 s36, s62
  s_mov_b32 s37, s63
  s_mov_b32 s38, 256
  s_mov_b32 s39, 0x20000
  s_cmp_ge_u32 s40, 4
  s_cbranch_scc1 L_C_p1
  s_cmp_lg_u32 s40, 0
  s_cbranch_scc1 L_w0_1
  v_mov_b32 v5, 0
  s_mov_b32 exec_lo, -1
  s_mov_b32 exec_hi, 0
  v_lshlrev_b32 v4, 2, v3
  v_add_u32 v4, 159936, v4
  ds_write_b32 v4, v5
  s_mov_b64 exec, -1
L_w0_1:
  v_and_b32 v4, 31, v3
  v_lshrrev_b32 v5, 5, v3
  v_bfe_u32 v6, v4, 1, 3
  v_xor_b32 v5, v5, v6
  v_lshlrev_b32 v5, 4, v5
  v_lshl_add_u32 v5, v4, 7, v5
  v_and_b32 v6, 1, v2
  v_lshl_add_u32 v5, v6, 12, v5
  v_xor_b32 v96, 0, v5
  v_xor_b32 v97, 32, v5
  v_xor_b32 v98, 64, v5
  v_xor_b32 v99, 96, v5
  v_and_b32 v4, 15, v3
  v_lshrrev_b32 v5, 5, v3
  v_lshlrev_b32 v5, 3, v5
  v_lshrrev_b32 v6, 2, v4
  v_add_u32 v5, v5, v6
  v_bfe_u32 v7, v3, 4, 1
  v_lshlrev_b32 v7, 5, v7
  v_and_b32 v8, 3, v4
  v_lshl_add_u32 v7, v8, 3, v7
  v_add_u32 v7, 65536, v7
  v_lshrrev_b32 v8, 1, v2
  v_xor_b32 v9, v8, v6
  v_lshlrev_b32 v9, 6, v9
  v_lshl_add_u32 v9, v5, 8, v9
  v_add_u32 v100, v9, v7
  v_xor_b32 v101, 128, v100
  s_lshl_b32 s48, s43, 1
  s_and_b32 s49, s41, 1
  s_add_u32 s48, s48, s49
  s_lshl_b32 s48, s48, 10
  s_lshl_b32 s49, s44, 1
  s_lshr_b32 s50, s41, 1
  s_add_u32 s49, s49, s50
  s_lshl_b32 s49, s49, 17
  s_add_u32 s48, s48, s49
  s_add_u32 s49, s48, 0
  s_add_u32 s50, s48, 65536
  s_add_u32 s51, s48, 2097152
  s_add_u32 s52, s48, 2162688
  s_add_u32 s53, s48, 4194304
  v_bfe_u32 v5, v3, 4, 1
  v_lshlrev_b32 v5, 16, v5
  v_lshrrev_b32 v6, 5, v3
  v_lshlrev_b32 v6, 8, v6
  v_and_b32 v7, 15, v3
  v_lshlrev_b32 v7, 4, v7
  v_add3_u32 v5, v5, v6, v7
  s_waitcnt lgkmcnt(0)
  s_barrier
  ds_read_b128 v[64:67], v96 offset:0
  ds_read_b64_tr_b16 v[72:73], v100 offset:0
  ds_read_b64_tr_b16 v[74:75], v100 offset:1024
  ds_read_b64_tr_b16 v[76:77], v101 offset:0
  ds_read_b64_tr_b16 v[78:79], v101 offset:1024
  ds_read_b128 v[68:71], v97 offset:0
  ds_read_b64_tr_b16 v[80:81], v100 offset:4096
  ds_read_b64_tr_b16 v[82:83], v100 offset:5120
  ds_read_b64_tr_b16 v[84:85], v101 offset:4096
  ds_read_b64_tr_b16 v[86:87], v101 offset:5120
  s_waitcnt lgkmcnt(5)
  v_mfma_f32_32x32x16_bf16 v[16:31], v[72:75], v[64:67], 0
  v_mfma_f32_32x32x16_bf16 v[32:47], v[64:67], v[76:79], 0
  ds_read_b128 v[64:67], v98 offset:0
  ds_read_b64_tr_b16 v[72:73], v100 offset:8192
  ds_read_b64_tr_b16 v[74:75], v100 offset:9216
  ds_read_b64_tr_b16 v[76:77], v101 offset:8192
  ds_read_b64_tr_b16 v[78:79], v101 offset:9216
  s_waitcnt lgkmcnt(5)
  v_mfma_f32_32x32x16_bf16 v[16:31], v[80:83], v[68:71], v[16:31]
  v_mfma_f32_32x32x16_bf16 v[32:47], v[68:71], v[84:87], v[32:47]
  ds_read_b128 v[68:71], v99 offset:0
  ds_read_b64_tr_b16 v[80:81], v100 offset:12288
  ds_read_b64_tr_b16 v[82:83], v100 offset:13312
  ds_read_b64_tr_b16 v[84:85], v101 offset:12288
  ds_read_b64_tr_b16 v[86:87], v101 offset:13312
  s_waitcnt lgkmcnt(5)
  v_mfma_f32_32x32x16_bf16 v[16:31], v[72:75], v[64:67], v[16:31]
  v_mfma_f32_32x32x16_bf16 v[32:47], v[64:67], v[76:79], v[32:47]
  s_waitcnt lgkmcnt(0)
  s_barrier
  ds_read_b128 v[64:67], v96 offset:8192
  ds_read_b64_tr_b16 v[72:73], v100 offset:24576
  ds_read_b64_tr_b16 v[74:75], v100 offset:25600
  ds_read_b64_tr_b16 v[76:77], v101 offset:24576
  ds_read_b64_tr_b16 v[78:79], v101 offset:25600
  v_mfma_f32_32x32x16_bf16 v[16:31], v[80:83], v[68:71], v[16:31]
  v_mfma_f32_32x32x16_bf16 v[32:47], v[68:71], v[84:87], v[32:47]
  ds_read_b128 v[68:71], v97 offset:8192
  ds_read_b64_tr_b16 v[80:81], v100 offset:28672
  ds_read_b64_tr_b16 v[82:83], v100 offset:29696
  ds_read_b64_tr_b16 v[84:85], v101 offset:28672
  ds_read_b64_tr_b16 v[86:87], v101 offset:29696
  s_waitcnt lgkmcnt(5)
  v_mfma_f32_32x32x16_bf16 v[16:31], v[72:75], v[64:67], v[16:31]
  v_mfma_f32_32x32x16_bf16 v[32:47], v[64:67], v[76:79], v[32:47]
  ds_read_b128 v[64:67], v98 offset:8192
  ds_read_b64_tr_b16 v[72:73], v100 offset:32768
  ds_read_b64_tr_b16 v[74:75], v100 offset:33792
  ds_read_b64_tr_b16 v[76:77], v101 offset:32768
  ds_read_b64_tr_b16 v[78:79], v101 offset:33792
  s_waitcnt lgkmcnt(5)
  v_mfma_f32_32x32x16_bf16 v[16:31], v[80:83], v[68:71], v[16:31]
  v_mfma_f32_32x32x16_bf16 v[32:47], v[68:71], v[84:87], v[32:47]
  ds_read_b128 v[68:71], v99 offset:8192
  ds_read_b64_tr_b16 v[80:81], v100 offset:36864
  ds_read_b64_tr_b16 v[82:83], v100 offset:37888
  ds_read_b64_tr_b16 v[84:85], v101 offset:36864
  ds_read_b64_tr_b16 v[86:87], v101 offset:37888
  s_waitcnt lgkmcnt(5)
  v_mfma_f32_32x32x16_bf16 v[16:31], v[72:75], v[64:67], v[16:31]
  v_mfma_f32_32x32x16_bf16 v[32:47], v[64:67], v[76:79], v[32:47]
  s_waitcnt lgkmcnt(0)
  s_barrier
  ds_read_b128 v[64:67], v96 offset:16384
  ds_read_b64_tr_b16 v[72:73], v100 offset:49152
  ds_read_b64_tr_b16 v[74:75], v100 offset:50176
  ds_read_b64_tr_b16 v[76:77], v101 offset:49152
  ds_read_b64_tr_b16 v[78:79], v101 offset:50176
  v_mfma_f32_32x32x16_bf16 v[16:31], v[80:83], v[68:71], v[16:31]
  v_mfma_f32_32x32x16_bf16 v[32:47], v[68:71], v[84:87], v[32:47]
  ds_read_b128 v[68:71], v97 offset:16384
  ds_read_b64_tr_b16 v[80:81], v100 offset:53248
  ds_read_b64_tr_b16 v[82:83], v100 offset:54272
  ds_read_b64_tr_b16 v[84:85], v101 offset:53248
  ds_read_b64_tr_b16 v[86:87], v101 offset:54272
  s_waitcnt lgkmcnt(5)
  v_mfma_f32_32x32x16_bf16 v[16:31], v[72:75], v[64:67], v[16:31]
  v_mfma_f32_32x32x16_bf16 v[32:47], v[64:67], v[76:79], v[32:47]
  ds_read_b128 v[64:67], v98 offset:16384
  ds_read_b64_tr_b16 v[72:73], v100 offset:57344
  ds_read_b64_tr_b16 v[74:75], v100 offset:58368
  ds_read_b64_tr_b16 v[76:77], v101 offset:57344
  ds_read_b64_tr_b16 v[78:79], v101 offset:58368
  s_waitcnt lgkmcnt(5)
  v_mfma_f32_32x32x16_bf16 v[16:31], v[80:83], v[68:71], v[16:31]
  v_mfma_f32_32x32x16_bf16 v[32:47], v[68:71], v[84:87], v[32:47]
  ds_read_b128 v[68:71], v99 offset:16384
  ds_read_b64_tr_b16 v[80:81], v100 offset:61440
  ds_read_b64_tr_b16 v[82:83], v100 offset:62464
  ds_read_b64_tr_b16 v[84:85], v101 offset:61440
  ds_read_b64_tr_b16 v[86:87], v101 offset:62464
  s_waitcnt lgkmcnt(5)
  v_mfma_f32_32x32x16_bf16 v[16:31], v[72:75], v[64:67], v[16:31]
  v_mfma_f32_32x32x16_bf16 v[32:47], v[64:67], v[76:79], v[32:47]
  s_waitcnt lgkmcnt(0)
  s_barrier
  ds_read_b128 v[64:67], v96 offset:24576
  ds_read_b64_tr_b16 v[72:73], v100 offset:0
  ds_read_b64_tr_b16 v[74:75], v100 offset:1024
  ds_read_b64_tr_b16 v[76:77], v101 offset:0
  ds_read_b64_tr_b16 v[78:79], v101 offset:1024
  v_mfma_f32_32x32x16_bf16 v[16:31], v[80:83], v[68:71], v[16:31]
  v_mfma_f32_32x32x16_bf16 v[32:47], v[68:71], v[84:87], v[32:47]
  ds_read_b128 v[68:71], v97 offset:24576
  ds_read_b64_tr_b16 v[80:81], v100 offset:4096
  ds_read_b64_tr_b16 v[82:83], v100 offset:5120
  ds_read_b64_tr_b16 v[84:85], v101 offset:4096
  ds_read_b64_tr_b16 v[86:87], v101 offset:5120
  s_waitcnt lgkmcnt(5)
  v_mfma_f32_32x32x16_bf16 v[16:31], v[72:75], v[64:67], v[16:31]
  v_mfma_f32_32x32x16_bf16 v[32:47], v[64:67], v[76:79], v[32:47]
  ds_read_b128 v[64:67], v98 offset:24576
  ds_read_b64_tr_b16 v[72:73], v100 offset:8192
  ds_read_b64_tr_b16 v[74:75], v100 offset:9216
  ds_read_b64_tr_b16 v[76:77], v101 offset:8192
  ds_read_b64_tr_b16 v[78:79], v101 offset:9216
  s_waitcnt lgkmcnt(5)
  v_mfma_f32_32x32x16_bf16 v[16:31], v[80:83], v[68:71], v[16:31]
  v_mfma_f32_32x32x16_bf16 v[32:47], v[68:71], v[84:87], v[32:47]
  ds_read_b128 v[68:71], v99 offset:24576
  ds_read_b64_tr_b16 v[80:81], v100 offset:12288
  ds_read_b64_tr_b16 v[82:83], v100 offset:13312
  ds_read_b64_tr_b16 v[84:85], v101 offset:12288
  ds_read_b64_tr_b16 v[86:87], v101 offset:13312
  s_waitcnt lgkmcnt(5)
  v_mfma_f32_32x32x16_bf16 v[16:31], v[72:75], v[64:67], v[16:31]
  v_mfma_f32_32x32x16_bf16 v[32:47], v[64:67], v[76:79], v[32:47]
  s_waitcnt lgkmcnt(0)
  s_barrier
  ds_read_b128 v[64:67], v96 offset:32768
  ds_read_b64_tr_b16 v[72:73], v100 offset:24576
  ds_read_b64_tr_b16 v[74:75], v100 offset:25600
  ds_read_b64_tr_b16 v[76:77], v101 offset:24576
  ds_read_b64_tr_b16 v[78:79], v101 offset:25600
  v_mfma_f32_32x32x16_bf16 v[16:31], v[80:83], v[68:71], v[16:31]
  v_mfma_f32_32x32x16_bf16 v[32:47], v[68:71], v[84:87], v[32:47]
  ds_read_b128 v[68:71], v97 offset:32768
  ds_read_b64_tr_b16 v[80:81], v100 offset:28672
  ds_read_b64_tr_b16 v[82:83], v100 offset:29696
  ds_read_b64_tr_b16 v[84:85], v101 offset:28672
  ds_read_b64_tr_b16 v[86:87], v101 offset:29696
  s_waitcnt lgkmcnt(5)
  v_mfma_f32_32x32x16_bf16 v[16:31], v[72:75], v[64:67], v[16:31]
  v_mfma_f32_32x32x16_bf16 v[32:47], v[64:67], v[76:79], v[32:47]
  ds_read_b128 v[64:67], v98 offset:32768
  ds_read_b64_tr_b16 v[72:73], v100 offset:32768
  ds_read_b64_tr_b16 v[74:75], v100 offset:33792
  ds_read_b64_tr_b16 v[76:77], v101 offset:32768
  ds_read_b64_tr_b16 v[78:79], v101 offset:33792
  s_waitcnt lgkmcnt(5)
  v_mfma_f32_32x32x16_bf16 v[16:31], v[80:83], v[68:71], v[16:31]
  v_mfma_f32_32x32x16_bf16 v[32:47], v[68:71], v[84:87], v[32:47]
  ds_read_b128 v[68:71], v99 offset:32768
  ds_read_b64_tr_b16 v[80:81], v100 offset:36864
  ds_read_b64_tr_b16 v[82:83], v100 offset:37888
  ds_read_b64_tr_b16 v[84:85], v101 offset:36864
  ds_read_b64_tr_b16 v[86:87], v101 offset:37888
  s_waitcnt lgkmcnt(5)
  v_mfma_f32_32x32x16_bf16 v[16:31], v[72:75], v[64:67], v[16:31]
  v_mfma_f32_32x32x16_bf16 v[32:47], v[64:67], v[76:79], v[32:47]
  s_waitcnt lgkmcnt(0)
  s_barrier
  ds_read_b128 v[64:67], v96 offset:40960
  ds_read_b64_tr_b16 v[72:73], v100 offset:49152
  ds_read_b64_tr_b16 v[74:75], v100 offset:50176
  ds_read_b64_tr_b16 v[76:77], v101 offset:49152
  ds_read_b64_tr_b16 v[78:79], v101 offset:50176
  v_mfma_f32_32x32x16_bf16 v[16:31], v[80:83], v[68:71], v[16:31]
  v_mfma_f32_32x32x16_bf16 v[32:47], v[68:71], v[84:87], v[32:47]
  ds_read_b128 v[68:71], v97 offset:40960
  ds_read_b64_tr_b16 v[80:81], v100 offset:53248
  ds_read_b64_tr_b16 v[82:83], v100 offset:54272
  ds_read_b64_tr_b16 v[84:85], v101 offset:53248
  ds_read_b64_tr_b16 v[86:87], v101 offset:54272
  s_waitcnt lgkmcnt(5)
  v_mfma_f32_32x32x16_bf16 v[16:31], v[72:75], v[64:67], v[16:31]
  v_mfma_f32_32x32x16_bf16 v[32:47], v[64:67], v[76:79], v[32:47]
  ds_read_b128 v[64:67], v98 offset:40960
  ds_read_b64_tr_b16 v[72:73], v100 offset:57344
  ds_read_b64_tr_b16 v[74:75], v100 offset:58368
  ds_read_b64_tr_b16 v[76:77], v101 offset:57344
  ds_read_b64_tr_b16 v[78:79], v101 offset:58368
  s_waitcnt lgkmcnt(5)
  v_mfma_f32_32x32x16_bf16 v[16:31], v[80:83], v[68:71], v[16:31]
  v_mfma_f32_32x32x16_bf16 v[32:47], v[68:71], v[84:87], v[32:47]
  ds_read_b128 v[68:71], v99 offset:40960
  ds_read_b64_tr_b16 v[80:81], v100 offset:61440
  ds_read_b64_tr_b16 v[82:83], v100 offset:62464
  ds_read_b64_tr_b16 v[84:85], v101 offset:61440
  ds_read_b64_tr_b16 v[86:87], v101 offset:62464
  s_waitcnt lgkmcnt(5)
  v_mfma_f32_32x32x16_bf16 v[16:31], v[72:75], v[64:67], v[16:31]
  v_mfma_f32_32x32x16_bf16 v[32:47], v[64:67], v[76:79], v[32:47]
  s_waitcnt lgkmcnt(0)
  s_barrier
  ds_read_b128 v[64:67], v96 offset:49152
  ds_read_b64_tr_b16 v[72:73], v100 offset:0
  ds_read_b64_tr_b16 v[74:75], v100 offset:1024
  ds_read_b64_tr_b16 v[76:77], v101 offset:0
  ds_read_b64_tr_b16 v[78:79], v101 offset:1024
  v_mfma_f32_32x32x16_bf16 v[16:31], v[80:83], v[68:71], v[16:31]
  v_mfma_f32_32x32x16_bf16 v[32:47], v[68:71], v[84:87], v[32:47]
  ds_read_b128 v[68:71], v97 offset:49152
  ds_read_b64_tr_b16 v[80:81], v100 offset:4096
  ds_read_b64_tr_b16 v[82:83], v100 offset:5120
  ds_read_b64_tr_b16 v[84:85], v101 offset:4096
  ds_read_b64_tr_b16 v[86:87], v101 offset:5120
  s_waitcnt lgkmcnt(5)
  v_mfma_f32_32x32x16_bf16 v[16:31], v[72:75], v[64:67], v[16:31]
  v_mfma_f32_32x32x16_bf16 v[32:47], v[64:67], v[76:79], v[32:47]
  ds_read_b128 v[64:67], v98 offset:49152
  ds_read_b64_tr_b16 v[72:73], v100 offset:8192
  ds_read_b64_tr_b16 v[74:75], v100 offset:9216
  ds_read_b64_tr_b16 v[76:77], v101 offset:8192
  ds_read_b64_tr_b16 v[78:79], v101 offset:9216
  s_waitcnt lgkmcnt(5)
  v_mfma_f32_32x32x16_bf16 v[16:31], v[80:83], v[68:71], v[16:31]
  v_mfma_f32_32x32x16_bf16 v[32:47], v[68:71], v[84:87], v[32:47]
  ds_read_b128 v[68:71], v99 offset:49152
  ds_read_b64_tr_b16 v[80:81], v100 offset:12288
  ds_read_b64_tr_b16 v[82:83], v100 offset:13312
  ds_read_b64_tr_b16 v[84:85], v101 offset:12288
  ds_read_b64_tr_b16 v[86:87], v101 offset:13312
  s_waitcnt lgkmcnt(5)
  v_mfma_f32_32x32x16_bf16 v[16:31], v[72:75], v[64:67], v[16:31]
  v_mfma_f32_32x32x16_bf16 v[32:47], v[64:67], v[76:79], v[32:47]
  s_waitcnt lgkmcnt(0)
  s_barrier
  ds_read_b128 v[64:67], v96 offset:57344
  ds_read_b64_tr_b16 v[72:73], v100 offset:24576
  ds_read_b64_tr_b16 v[74:75], v100 offset:25600
  ds_read_b64_tr_b16 v[76:77], v101 offset:24576
  ds_read_b64_tr_b16 v[78:79], v101 offset:25600
  v_mfma_f32_32x32x16_bf16 v[16:31], v[80:83], v[68:71], v[16:31]
  v_mfma_f32_32x32x16_bf16 v[32:47], v[68:71], v[84:87], v[32:47]
  v_mov_b32 v8, 159956
  ds_read_b32 v9, v8
  s_waitcnt lgkmcnt(0)
  v_readfirstlane_b32 s42, v9
  v_mov_b32 v8, 159960
  ds_read_b32 v9, v8
  s_waitcnt lgkmcnt(0)
  v_readfirstlane_b32 s54, v9
  ds_read_b128 v[68:71], v97 offset:57344
  ds_read_b64_tr_b16 v[80:81], v100 offset:28672
  ds_read_b64_tr_b16 v[82:83], v100 offset:29696
  ds_read_b64_tr_b16 v[84:85], v101 offset:28672
  ds_read_b64_tr_b16 v[86:87], v101 offset:29696
  s_waitcnt lgkmcnt(5)
  v_mfma_f32_32x32x16_bf16 v[16:31], v[72:75], v[64:67], v[16:31]
  v_mfma_f32_32x32x16_bf16 v[32:47], v[64:67], v[76:79], v[32:47]
  ds_read_b128 v[64:67], v98 offset:57344
  ds_read_b64_tr_b16 v[72:73], v100 offset:32768
  ds_read_b64_tr_b16 v[74:75], v100 offset:33792
  ds_read_b64_tr_b16 v[76:77], v101 offset:32768
  ds_read_b64_tr_b16 v[78:79], v101 offset:33792
  s_waitcnt lgkmcnt(5)
  v_mfma_f32_32x32x16_bf16 v[16:31], v[80:83], v[68:71], v[16:31]
  v_mfma_f32_32x32x16_bf16 v[32:47], v[68:71], v[84:87], v[32:47]
  ds_read_b128 v[68:71], v99 offset:57344
  ds_read_b64_tr_b16 v[80:81], v100 offset:36864
  ds_read_b64_tr_b16 v[82:83], v100 offset:37888
  ds_read_b64_tr_b16 v[84:85], v101 offset:36864
  ds_read_b64_tr_b16 v[86:87], v101 offset:37888
  s_waitcnt lgkmcnt(5)
  v_mfma_f32_32x32x16_bf16 v[16:31], v[72:75], v[64:67], v[16:31]
  v_mfma_f32_32x32x16_bf16 v[32:47], v[64:67], v[76:79], v[32:47]
  s_waitcnt lgkmcnt(0)
  v_mfma_f32_32x32x16_bf16 v[16:31], v[80:83], v[68:71], v[16:31]
  v_mfma_f32_32x32x16_bf16 v[32:47], v[68:71], v[84:87], v[32:47]
  s_nop 10
  v_cvt_pk_bf16_f32 v112, v16, v17
  v_cvt_pk_bf16_f32 v113, v18, v19
  v_cvt_pk_bf16_f32 v114, v20, v21
  v_cvt_pk_bf16_f32 v115, v22, v23
  v_cvt_pk_bf16_f32 v116, v24, v25
  v_cvt_pk_bf16_f32 v117, v26, v27
  v_cvt_pk_bf16_f32 v118, v28, v29
  v_cvt_pk_bf16_f32 v119, v30, v31
  v_cvt_pk_bf16_f32 v120, v32, v33
  v_cvt_pk_bf16_f32 v121, v34, v35
  v_cvt_pk_bf16_f32 v122, v36, v37
  v_cvt_pk_bf16_f32 v123, v38, v39
  v_cvt_pk_bf16_f32 v124, v40, v41
  v_cvt_pk_bf16_f32 v125, v42, v43
  v_cvt_pk_bf16_f32 v126, v44, v45
  v_cvt_pk_bf16_f32 v127, v46, v47
  s_cmp_eq_u32 s54, 0
  s_cbranch_scc1 L_slow_2
  buffer_store_dwordx4 v[112:115], v1, s[20:23], s51 offen
  buffer_store_dwordx4 v[116:119], v1, s[20:23], s52 offen
  buffer_store_dwordx4 v[120:123], v5, s[20:23], s53 offen
  buffer_store_dwordx4 v[124:127], v5, s[20:23], s53 offen offset:512
  s_branch L_join_3
L_slow_2:
  buffer_store_dwordx4 v[112:115], v1, s[20:23], s51 offen sc1
  buffer_store_dwordx4 v[116:119], v1, s[20:23], s52 offen sc1
  buffer_store_dwordx4 v[120:123], v5, s[20:23], s53 offen sc1
  buffer_store_dwordx4 v[124:127], v5, s[20:23], s53 offen offset:512 sc1
L_join_3:
  s_waitcnt vmcnt(0)
  s_mov_b64 exec, 1
  v_mov_b32 v8, 160008
  v_mov_b32 v9, 1
  ds_add_rtn_u32 v9, v8, v9
  s_waitcnt lgkmcnt(0)
  v_readfirstlane_b32 s70, v9
  s_nop 0
  s_cmp_lg_u32 s70, 3
  s_cbranch_scc1 L_arr_4
  s_lshl_b32 s48, s44, 7
  s_lshl_b32 s55, s43, 2
  s_add_u32 s48, s48, s55
  s_add_u32 s48, s48, 17564672
  v_mov_b32 v6, 0
  v_mov_b32 v7, s42
  s_cmp_eq_u32 s54, 0
  s_cbranch_scc1 L_slow_5
  buffer_store_dword v7, v6, s[20:23], s48 offen
  s_branch L_join_6
L_slow_5:
  buffer_store_dword v7, v6, s[20:23], s48 offen sc1
L_join_6:
L_arr_4:
  s_mov_b64 exec, -1
  s_branch L_att_entry
L_C_p1:
  s_cmp_lg_u32 s40, 4
  s_cbranch_scc1 L_pf_7
  s_getpc_b64 s[24:25]
L_pf_base:
  s_mov_b32 s26, L_code_end-L_pf_base
  s_mov_b32 s27, 0x20000
  s_lshr_b32 s48, s2, 3
  s_lshl_b32 s48, s48, 11
  buffer_load_dwordx4 v[148:151], v1, s[24:27], s48 offen
  buffer_load_dwordx4 v[152:155], v1, s[24:27], s48 offen offset:1024
L_pf_7:
  s_cmp_lg_u32 s40, 4
  s_cbranch_scc1 L_tw_8
  s_cmp_lg_u32 s2, 0
  s_cbranch_scc1 L_tw_8
  s_memrealtime s[48:49]
  v_mov_b32 v4, 0
  v_mov_b32 v5, 0
  v_mov_b32 v6, 0
  v_mov_b32 v7, 0
  s_mov_b32 s50, 17571840
  buffer_store_dwordx4 v[4:7], v1, s[20:23], s50 offen sc1
  s_mov_b32 s50, 17572864
  buffer_store_dwordx4 v[4:7], v1, s[20:23], s50 offen sc1
  s_mov_b32 s50, 17573888
  buffer_store_dwordx4 v[4:7], v1, s[20:23], s50 offen sc1
  s_mov_b32 s50, 17574912
  buffer_store_dwordx4 v[4:7], v1, s[20:23], s50 offen sc1
  s_waitcnt vmcnt(0) lgkmcnt(0)
  s_or_b32 s48, s48, 1
  v_mov_b32 v4, 16
  v_mov_b32 v5, s48
  s_mov_b64 exec, 1
  buffer_store_dword v5, v4, s[36:39], 0 offen sc1
  s_mov_b64 exec, -1
L_tw_8:
  v_and_b32 v4, 31, v3
  v_lshrrev_b32 v5, 5, v3
  v_bfe_u32 v6, v4, 1, 3
  v_xor_b32 v5, v5, v6
  v_lshlrev_b32 v5, 4, v5
  v_lshl_add_u32 v5, v4, 7, v5
  v_and_b32 v6, 1, v2
  v_lshl_add_u32 v5, v6, 12, v5
  v_xor_b32 v96, 0, v5
  v_xor_b32 v97, 32, v5
  v_xor_b32 v98, 64, v5
  v_xor_b32 v99, 96, v5
  v_and_b32 v4, 15, v3
  v_lshrrev_b32 v5, 5, v3
  v_lshlrev_b32 v5, 3, v5
  v_lshrrev_b32 v6, 2, v4
  v_add_u32 v5, v5, v6
  v_bfe_u32 v7, v3, 4, 1
  v_lshlrev_b32 v7, 5, v7
  v_and_b32 v8, 3, v4
  v_lshl_add_u32 v7, v8, 3, v7
  v_add_u32 v7, 81920, v7
  v_lshrrev_b32 v8, 1, v2
  v_bfe_u32 v9, v3, 3, 1
  v_xor_b32 v9, v8, v9
  v_lshlrev_b32 v9, 6, v9
  v_lshl_add_u32 v9, v5, 7, v9
  v_add_u32 v100, v9, v7
  s_barrier
  ds_read_b128 v[80:83], v96 offset:0
  ds_read_b64_tr_b16 v[88:89], v100 offset:0
  ds_read_b64_tr_b16 v[90:91], v100 offset:512
  ds_read_b128 v[84:87], v97 offset:0
  ds_read_b64_tr_b16 v[92:93], v100 offset:2048
  ds_read_b64_tr_b16 v[94:95], v100 offset:2560
  s_waitcnt lgkmcnt(3)
  v_mfma_f32_32x32x16_bf16 v[64:79], v[88:91], v[80:83], 0
  v_and_b32 v61, 31, v3
  v_lshrrev_b32 v62, 5, v3
  v_cvt_f32_u32 v61, v61
  v_cvt_f32_u32 v62, v62
  v_mul_f32 v56, 0x3d000000, v61
  v_mul_f32 v57, 0x41000000, v62
  v_mul_f32 v57, v57, v56
  v_mov_b32 v10, 0x0
  v_fma_f32 v10, v56, v10, v57
  v_cos_f32 v12, v10
  v_sin_f32 v14, v10
  v_mov_b32 v11, 0x3f800000
  v_fma_f32 v11, v56, v11, v57
  v_cos_f32 v13, v11
  v_sin_f32 v15, v11
  v_cvt_pk_bf16_f32 v16, v12, v13
  v_cvt_pk_bf16_f32 v24, -v14, -v15
  v_mov_b32 v10, 0x40000000
  v_fma_f32 v10, v56, v10, v57
  v_cos_f32 v12, v10
  v_sin_f32 v14, v10
  v_mov_b32 v11, 0x40400000
  v_fma_f32 v11, v56, v11, v57
  v_cos_f32 v13, v11
  v_sin_f32 v15, v11
  v_cvt_pk_bf16_f32 v17, v12, v13
  v_cvt_pk_bf16_f32 v25, -v14, -v15
  v_mov_b32 v10, 0x40800000
  v_fma_f32 v10, v56, v10, v57
  v_cos_f32 v12, v10
  v_sin_f32 v14, v10
  v_mov_b32 v11, 0x40a00000
  v_fma_f32 v11, v56, v11, v57
  v_cos_f32 v13, v11
  v_sin_f32 v15, v11
  v_cvt_pk_bf16_f32 v18, v12, v13
  v_cvt_pk_bf16_f32 v26, -v14, -v15
  v_mov_b32 v10, 0x40c00000
  v_fma_f32 v10, v56, v10, v57
  v_cos_f32 v12, v10
  v_sin_f32 v14, v10
  v_mov_b32 v11, 0x40e00000
  v_fma_f32 v11, v56, v11, v57
  v_cos_f32 v13, v11
  v_sin_f32 v15, v11
  v_cvt_pk_bf16_f32 v19, v12, v13
  v_cvt_pk_bf16_f32 v27, -v14, -v15
  ds_read_b128 v[80:83], v98 offset:0
  ds_read_b64_tr_b16 v[88:89], v100 offset:4096
  ds_read_b64_tr_b16 v[90:91], v100 offset:4608
  s_waitcnt lgkmcnt(3)
  v_mfma_f32_32x32x16_bf16 v[64:79], v[92:95], v[84:87], v[64:79]
  ds_read_b128 v[84:87], v99 offset:0
  ds_read_b64_tr_b16 v[92:93], v100 offset:6144
  ds_read_b64_tr_b16 v[94:95], v100 offset:6656
  s_waitcnt lgkmcnt(3)
  v_mfma_f32_32x32x16_bf16 v[64:79], v[88:91], v[80:83], v[64:79]
  s_waitcnt lgkmcnt(0)
  s_barrier
  ds_read_b128 v[80:83], v96 offset:8192
  ds_read_b64_tr_b16 v[88:89], v100 offset:24576
  ds_read_b64_tr_b16 v[90:91], v100 offset:25088
  v_mfma_f32_32x32x16_bf16 v[64:79], v[92:95], v[84:87], v[64:79]
  ds_read_b128 v[84:87], v97 offset:8192
  ds_read_b64_tr_b16 v[92:93], v100 offset:26624
  ds_read_b64_tr_b16 v[94:95], v100 offset:27136
  s_waitcnt lgkmcnt(3)
  v_mfma_f32_32x32x16_bf16 v[64:79], v[88:91], v[80:83], v[64:79]
  s_cmp_lg_u32 s40, 4
  s_cbranch_scc1 L_w4_9
  v_mov_b32 v156, 16
  buffer_load_dword v156, v156, s[36:39], 0 offen sc1
L_w4_9:
  v_mul_f32 v56, 0x3d000000, v61
  v_mul_f32 v57, 0x41000000, v62
  v_mul_f32 v57, v57, v56
  v_mov_b32 v10, 0x41800000
  v_fma_f32 v10, v56, v10, v57
  v_cos_f32 v12, v10
  v_sin_f32 v14, v10
  v_mov_b32 v11, 0x41880000
  v_fma_f32 v11, v56, v11, v57
  v_cos_f32 v13, v11
  v_sin_f32 v15, v11
  v_cvt_pk_bf16_f32 v20, v12, v13
  v_cvt_pk_bf16_f32 v28, -v14, -v15
  v_mov_b32 v10, 0x41900000
  v_fma_f32 v10, v56, v10, v57
  v_cos_f32 v12, v10
  v_sin_f32 v14, v10
  v_mov_b32 v11, 0x41980000
  v_fma_f32 v11, v56, v11, v57
  v_cos_f32 v13, v11
  v_sin_f32 v15, v11
  v_cvt_pk_bf16_f32 v21, v12, v13
  v_cvt_pk_bf16_f32 v29, -v14, -v15
  v_mov_b32 v10, 0x41a00000
  v_fma_f32 v10, v56, v10, v57
  v_cos_f32 v12, v10
  v_sin_f32 v14, v10
  v_mov_b32 v11, 0x41a80000
  v_fma_f32 v11, v56, v11, v57
  v_cos_f32 v13, v11
  v_sin_f32 v15, v11
  v_cvt_pk_bf16_f32 v22, v12, v13
  v_cvt_pk_bf16_f32 v30, -v14, -v15
  v_mov_b32 v10, 0x41b00000
  v_fma_f32 v10, v56, v10, v57
  v_cos_f32 v12, v10
  v_sin_f32 v14, v10
  v_mov_b32 v11, 0x41b80000
  v_fma_f32 v11, v56, v11, v57
  v_cos_f32 v13, v11
  v_sin_f32 v15, v11
  v_cvt_pk_bf16_f32 v23, v12, v13
  v_cvt_pk_bf16_f32 v31, -v14, -v15
  ds_read_b128 v[80:83], v98 offset:8192
  ds_read_b64_tr_b16 v[88:89], v100 offset:28672
  ds_read_b64_tr_b16 v[90:91], v100 offset:29184
  s_waitcnt lgkmcnt(3)
  v_mfma_f32_32x32x16_bf16 v[64:79], v[92:95], v[84:87], v[64:79]
  ds_read_b128 v[84:87], v99 offset:8192
  ds_read_b64_tr_b16 v[92:93], v100 offset:30720
  ds_read_b64_tr_b16 v[94:95], v100 offset:31232
  s_waitcnt lgkmcnt(3)
  v_mfma_f32_32x32x16_bf16 v[64:79], v[88:91], v[80:83], v[64:79]
  s_waitcnt lgkmcnt(0)
  s_barrier
  ds_read_b128 v[80:83], v96 offset:16384
  ds_read_b64_tr_b16 v[88:89], v100 offset:49152
  ds_read_b64_tr_b16 v[90:91], v100 offset:49664
  v_mfma_f32_32x32x16_bf16 v[64:79], v[92:95], v[84:87], v[64:79]
  ds_read_b128 v[84:87], v97 offset:16384
  ds_read_b64_tr_b16 v[92:93], v100 offset:51200
  ds_read_b64_tr_b16 v[94:95], v100 offset:51712
  s_waitcnt lgkmcnt(3)
  v_mfma_f32_32x32x16_bf16 v[64:79], v[88:91], v[80:83], v[64:79]
  s_cmp_lg_u32 s40, 4
  s_cbranch_scc1 L_w4_10
  s_waitcnt vmcnt(0)
L_tok_11:
  s_nop 0
  v_readfirstlane_b32 s42, v156
  s_nop 0
  s_cmp_lg_u32 s42, 0
  s_cbranch_scc1 L_tokok_12
  s_add_u32 s71, s71, 1
  s_cmp_gt_u32 s71, 131072
  s_cbranch_scc1 L_tokok_12
  s_sleep 2
  v_mov_b32 v156, 16
  buffer_load_dword v156, v156, s[36:39], 0 offen sc1
  s_waitcnt vmcnt(0)
  s_branch L_tok_11
L_tokok_12:
  s_getreg_b32 s59, hwreg(HW_REG_XCC_ID)
  s_and_b32 s59, s59, 7
  s_lshl_b32 s59, s59, 3
  s_lshl_b64 s[60:61], 1, s59
  s_and_b32 s62, s2, 7
  s_lshl_b32 s62, s62, 7
  s_add_u32 s62, s62, 17573888
  v_mov_b32 v156, 0
  v_mov_b32 v158, s60
  v_mov_b32 v159, s61
  s_mov_b64 exec, 1
  buffer_atomic_add_x2 v[158:159], v156, s[20:23], s62 offen sc1
  s_mov_b64 exec, -1
  s_mov_b64 exec, 1
  v_mov_b32 v160, 159956
  v_mov_b32 v161, s42
  ds_write_b32 v160, v161
  s_mov_b64 exec, -1
L_w4_10:
  s_lshr_b32 s48, s2, 6
  s_lshl_b32 s48, s48, 2
  s_and_b32 s49, s41, 1
  s_lshl_b32 s49, s49, 1
  s_add_u32 s48, s48, s49
  s_lshr_b32 s49, s41, 1
  s_lshl_b32 s49, s49, 4
  s_add_u32 s48, s48, s49
  s_lshl_b32 s48, s48, 6
  s_and_b32 s49, s2, 63
  s_add_u32 s48, s48, s49
  s_lshl_b32 s48, s48, 10
  s_lshl_b32 s49, s41, 10
  s_add_u32 s49, s49, 0
  s_mov_b32 m0, s49
  s_add_u32 s49, s49, 4224
  buffer_load_dwordx4 v1, s[12:15], s48 offen lds
  s_mov_b32 m0, s49
  s_add_u32 s48, s48, 65536
  buffer_load_dwordx4 v1, s[12:15], s48 offen lds
  s_and_b32 s57, s2, 1
  s_and_b32 s52, s2, 15
  s_lshr_b32 s53, s2, 4
  s_lshl_b32 s53, s53, 7
  s_add_u32 s52, s52, s53
  s_and_b32 s53, s41, 1
  s_lshl_b32 s53, s53, 4
  s_add_u32 s52, s52, s53
  s_mul_i32 s52, s52, 514
  s_lshl_b32 s53, s57, 1
  s_sub_u32 s52, s52, s53
  s_mul_i32 s53, s41, 2304
  s_add_u32 s53, s53, 139264
  s_mov_b32 exec_hi, 1
  s_mov_b32 m0, s53
  s_add_u32 s53, s53, 576
  buffer_load_dwordx4 v1, s[16:19], s52 offen lds
  s_add_u32 s52, s52, 16448
  s_mov_b32 m0, s53
  s_add_u32 s53, s53, 576
  buffer_load_dwordx4 v1, s[16:19], s52 offen lds
  s_add_u32 s52, s52, 16448
  s_mov_b32 m0, s53
  s_add_u32 s53, s53, 576
  buffer_load_dwordx4 v1, s[16:19], s52 offen lds
  s_add_u32 s52, s52, 16448
  s_mov_b32 m0, s53
  s_add_u32 s53, s53, 576
  buffer_load_dwordx4 v1, s[16:19], s52 offen lds
  s_mov_b64 exec, -1
  v_and_b32 v4, 15, v3
  v_and_b32 v7, 3, v4
  v_lshlrev_b32 v7, 3, v7
  v_lshrrev_b32 v5, 5, v3
  v_lshlrev_b32 v5, 3, v5
  v_lshrrev_b32 v6, 2, v4
  v_add_u32 v5, v5, v6
  v_lshlrev_b32 v5, 5, v5
  v_bfe_u32 v6, v3, 4, 1
  v_mul_u32_u24 v6, 4224, v6
  v_add3_u32 v5, v5, v6, v7
  v_lshlrev_b32 v6, 10, v2
  v_add_u32 v5, v5, v6
  v_add_u32 v8, 0, v5
  v_and_b32 v4, 31, v3
  v_lshlrev_b32 v5, 5, v4
  v_lshrrev_b32 v4, 3, v4
  v_lshl_add_u32 v5, v4, 4, v5
  v_lshrrev_b32 v6, 5, v3
  v_mul_u32_u24 v6, 2176, v6
  v_lshlrev_b32 v7, 2, v2
  v_add3_u32 v5, v5, v6, v7
  v_add_u32 v9, 148480, v5
  ds_read_b128 v[80:83], v98 offset:16384
  ds_read_b64_tr_b16 v[88:89], v100 offset:53248
  ds_read_b64_tr_b16 v[90:91], v100 offset:53760
  s_waitcnt lgkmcnt(3)
  v_mfma_f32_32x32x16_bf16 v[64:79], v[92:95], v[84:87], v[64:79]
  ds_read_b128 v[84:87], v99 offset:16384
  ds_read_b64_tr_b16 v[92:93], v100 offset:55296
  ds_read_b64_tr_b16 v[94:95], v100 offset:55808
  s_waitcnt lgkmcnt(3)
  v_mfma_f32_32x32x16_bf16 v[64:79], v[88:91], v[80:83], v[64:79]
  s_waitcnt lgkmcnt(0)
  s_barrier
  ds_read_b128 v[80:83], v96 offset:24576
  ds_read_b64_tr_b16 v[88:89], v100 offset:0
  ds_read_b64_tr_b16 v[90:91], v100 offset:512
  v_mfma_f32_32x32x16_bf16 v[64:79], v[92:95], v[84:87], v[64:79]
  ds_read_b128 v[84:87], v97 offset:24576
  ds_read_b64_tr_b16 v[92:93], v100 offset:2048
  ds_read_b64_tr_b16 v[94:95], v100 offset:2560
  s_waitcnt lgkmcnt(3)
  v_mfma_f32_32x32x16_bf16 v[64:79], v[88:91], v[80:83], v[64:79]
  v_and_b32 v56, 31, v3
  v_lshrrev_b32 v57, 1, v56
  v_cvt_f32_u32 v57, v57
  v_mul_f32 v57, 0x3d800000, v57
  v_and_b32 v58, 1, v56
  v_cvt_f32_u32 v58, v58
  v_mul_f32 v58, 0x3e800000, v58
  v_mul_f32 v59, 4.0, v62
  v_fma_f32 v58, v57, v59, v58
  v_cmp_ge_u32 vcc, 16, v56
  v_mov_b32 v60, 1.0
  s_nop 0
  v_cndmask_b32 v60, 0, v60, vcc
  v_mov_b32 v10, 0x0
  v_fma_f32 v10, v57, v10, v58
  v_cos_f32 v12, v10
  v_mov_b32 v11, 0x3f800000
  v_fma_f32 v11, v57, v11, v58
  v_cos_f32 v13, v11
  v_mul_f32 v12, v12, v60
  v_mul_f32 v13, v13, v60
  v_cvt_pk_bf16_f32 v32, v12, v13
  v_mov_b32 v10, 0x40000000
  v_fma_f32 v10, v57, v10, v58
  v_cos_f32 v12, v10
  v_mov_b32 v11, 0x40400000
  v_fma_f32 v11, v57, v11, v58
  v_cos_f32 v13, v11
  v_mul_f32 v12, v12, v60
  v_mul_f32 v13, v13, v60
  v_cvt_pk_bf16_f32 v33, v12, v13
  v_mov_b32 v10, 0x41000000
  v_fma_f32 v10, v57, v10, v58
  v_cos_f32 v12, v10
  v_mov_b32 v11, 0x41100000
  v_fma_f32 v11, v57, v11, v58
  v_cos_f32 v13, v11
  v_mul_f32 v12, v12, v60
  v_mul_f32 v13, v13, v60
  v_cvt_pk_bf16_f32 v34, v12, v13
  v_mov_b32 v10, 0x41200000
  v_fma_f32 v10, v57, v10, v58
  v_cos_f32 v12, v10
  v_mov_b32 v11, 0x41300000
  v_fma_f32 v11, v57, v11, v58
  v_cos_f32 v13, v11
  v_mul_f32 v12, v12, v60
  v_mul_f32 v13, v13, v60
  v_cvt_pk_bf16_f32 v35, v12, v13
  ds_read_b128 v[80:83], v98 offset:24576
  ds_read_b64_tr_b16 v[88:89], v100 offset:4096
  ds_read_b64_tr_b16 v[90:91], v100 offset:4608
  s_waitcnt lgkmcnt(3)
  v_mfma_f32_32x32x16_bf16 v[64:79], v[92:95], v[84:87], v[64:79]
  ds_read_b128 v[84:87], v99 offset:24576
  ds_read_b64_tr_b16 v[92:93], v100 offset:6144
  ds_read_b64_tr_b16 v[94:95], v100 offset:6656
  s_waitcnt lgkmcnt(3)
  v_mfma_f32_32x32x16_bf16 v[64:79], v[88:91], v[80:83], v[64:79]
  s_waitcnt lgkmcnt(0)
  s_barrier
  ds_read_b128 v[80:83], v96 offset:32768
  ds_read_b64_tr_b16 v[88:89], v100 offset:24576
  ds_read_b64_tr_b16 v[90:91], v100 offset:25088
  v_mfma_f32_32x32x16_bf16 v[64:79], v[92:95], v[84:87], v[64:79]
  ds_read_b128 v[84:87], v97 offset:32768
  ds_read_b64_tr_b16 v[92:93], v100 offset:26624
  ds_read_b64_tr_b16 v[94:95], v100 offset:27136
  s_waitcnt lgkmcnt(3)
  v_mfma_f32_32x32x16_bf16 v[64:79], v[88:91], v[80:83], v[64:79]
  s_cmp_lg_u32 s40, 4
  s_cbranch_scc1 L_w4_13
  v_mov_b32 v156, 0
  buffer_load_dwordx2 v[158:159], v156, s[20:23], s62 offen sc1
L_w4_13:
  v_and_b32 v56, 31, v3
  v_lshrrev_b32 v57, 1, v56
  v_cvt_f32_u32 v57, v57
  v_mul_f32 v57, 0x3d800000, v57
  v_and_b32 v58, 1, v56
  v_cvt_f32_u32 v58, v58
  v_mul_f32 v58, 0x3e800000, v58
  v_mul_f32 v59, 4.0, v62
  v_fma_f32 v58, v57, v59, v58
  v_cmp_ge_u32 vcc, 16, v56
  v_mov_b32 v60, 1.0
  s_nop 0
  v_cndmask_b32 v60, 0, v60, vcc
  v_mov_b32 v10, 0x0
  v_fma_f32 v10, v57, v10, v58
  v_add_f32 v10, 0xbe800000, v10
  v_cos_f32 v12, v10
  v_mov_b32 v11, 0x3f800000
  v_fma_f32 v11, v57, v11, v58
  v_add_f32 v11, 0xbe800000, v11
  v_cos_f32 v13, v11
  v_mul_f32 v12, v12, v60
  v_mul_f32 v13, v13, v60
  v_cvt_pk_bf16_f32 v36, v12, v13
  v_mov_b32 v10, 0x40000000
  v_fma_f32 v10, v57, v10, v58
  v_add_f32 v10, 0xbe800000, v10
  v_cos_f32 v12, v10
  v_mov_b32 v11, 0x40400000
  v_fma_f32 v11, v57, v11, v58
  v_add_f32 v11, 0xbe800000, v11
  v_cos_f32 v13, v11
  v_mul_f32 v12, v12, v60
  v_mul_f32 v13, v13, v60
  v_cvt_pk_bf16_f32 v37, v12, v13
  v_mov_b32 v10, 0x41000000
  v_fma_f32 v10, v57, v10, v58
  v_add_f32 v10, 0xbe800000, v10
  v_cos_f32 v12, v10
  v_mov_b32 v11, 0x41100000
  v_fma_f32 v11, v57, v11, v58
  v_add_f32 v11, 0xbe800000, v11
  v_cos_f32 v13, v11
  v_mul_f32 v12, v12, v60
  v_mul_f32 v13, v13, v60
  v_cvt_pk_bf16_f32 v38, v12, v13
  v_mov_b32 v10, 0x41200000
  v_fma_f32 v10, v57, v10, v58
  v_add_f32 v10, 0xbe800000, v10
  v_cos_f32 v12, v10
  v_mov_b32 v11, 0x41300000
  v_fma_f32 v11, v57, v11, v58
  v_add_f32 v11, 0xbe800000, v11
  v_cos_f32 v13, v11
  v_mul_f32 v12, v12, v60
  v_mul_f32 v13, v13, v60
  v_cvt_pk_bf16_f32 v39, v12, v13
  ds_read_b128 v[80:83], v98 offset:32768
  ds_read_b64_tr_b16 v[88:89], v100 offset:28672
  ds_read_b64_tr_b16 v[90:91], v100 offset:29184
  s_waitcnt lgkmcnt(3)
  v_mfma_f32_32x32x16_bf16 v[64:79], v[92:95], v[84:87], v[64:79]
  ds_read_b128 v[84:87], v99 offset:32768
  ds_read_b64_tr_b16 v[92:93], v100 offset:30720
  ds_read_b64_tr_b16 v[94:95], v100 offset:31232
  s_waitcnt lgkmcnt(3)
  v_mfma_f32_32x32x16_bf16 v[64:79], v[88:91], v[80:83], v[64:79]
  s_waitcnt lgkmcnt(0)
  s_barrier
  ds_read_b128 v[80:83], v96 offset:40960
  ds_read_b64_tr_b16 v[88:89], v100 offset:49152
  ds_read_b64_tr_b16 v[90:91], v100 offset:49664
  v_mfma_f32_32x32x16_bf16 v[64:79], v[92:95], v[84:87], v[64:79]
  ds_read_b128 v[84:87], v97 offset:40960
  ds_read_b64_tr_b16 v[92:93], v100 offset:51200
  ds_read_b64_tr_b16 v[94:95], v100 offset:51712
  s_waitcnt lgkmcnt(3)
  v_mfma_f32_32x32x16_bf16 v[64:79], v[88:91], v[80:83], v[64:79]
  v_mul_f32 v57, 0x3b000000, v61
  v_mul_f32 v59, 4.0, v62
  v_mul_f32 v58, v57, v59
  v_mov_b32 v10, 0x0
  v_fma_f32 v10, v57, v10, v58
  v_cos_f32 v40, v10
  v_sin_f32 v48, v10
  v_mov_b32 v10, 0x3f800000
  v_fma_f32 v10, v57, v10, v58
  v_cos_f32 v41, v10
  v_sin_f32 v49, v10
  v_mov_b32 v10, 0x40000000
  v_fma_f32 v10, v57, v10, v58
  v_cos_f32 v42, v10
  v_sin_f32 v50, v10
  v_mov_b32 v10, 0x40400000
  v_fma_f32 v10, v57, v10, v58
  v_cos_f32 v43, v10
  v_sin_f32 v51, v10
  v_mov_b32 v10, 0x41000000
  v_fma_f32 v10, v57, v10, v58
  v_cos_f32 v44, v10
  v_sin_f32 v52, v10
  v_mov_b32 v10, 0x41100000
  v_fma_f32 v10, v57, v10, v58
  v_cos_f32 v45, v10
  v_sin_f32 v53, v10
  v_mov_b32 v10, 0x41200000
  v_fma_f32 v10, v57, v10, v58
  v_cos_f32 v46, v10
  v_sin_f32 v54, v10
  v_mov_b32 v10, 0x41300000
  v_fma_f32 v10, v57, v10, v58
  v_cos_f32 v47, v10
  v_sin_f32 v55, v10
  ds_read_b128 v[80:83], v98 offset:40960
  ds_read_b64_tr_b16 v[88:89], v100 offset:53248
  ds_read_b64_tr_b16 v[90:91], v100 offset:53760
  s_waitcnt lgkmcnt(3)
  v_mfma_f32_32x32x16_bf16 v[64:79], v[92:95], v[84:87], v[64:79]
  ds_read_b128 v[84:87], v99 offset:40960
  ds_read_b64_tr_b16 v[92:93], v100 offset:55296
  ds_read_b64_tr_b16 v[94:95], v100 offset:55808
  s_waitcnt lgkmcnt(3)
  v_mfma_f32_32x32x16_bf16 v[64:79], v[88:91], v[80:83], v[64:79]
  s_waitcnt lgkmcnt(0)
  s_barrier
  ds_read_b128 v[80:83], v96 offset:49152
  ds_read_b64_tr_b16 v[88:89], v100 offset:0
  ds_read_b64_tr_b16 v[90:91], v100 offset:512
  v_mfma_f32_32x32x16_bf16 v[64:79], v[92:95], v[84:87], v[64:79]
  ds_read_b128 v[84:87], v97 offset:49152
  ds_read_b64_tr_b16 v[92:93], v100 offset:2048
  ds_read_b64_tr_b16 v[94:95], v100 offset:2560
  s_waitcnt lgkmcnt(3)
  v_mfma_f32_32x32x16_bf16 v[64:79], v[88:91], v[80:83], v[64:79]
  s_cmp_lg_u32 s40, 4
  s_cbranch_scc1 L_w4_14
  s_waitcnt vmcnt(0)
  s_lshl_b64 s[60:61], s[60:61], 5
  v_readfirstlane_b32 s56, v158
  v_readfirstlane_b32 s57, v159
  s_nop 0
  s_cmp_eq_u64 s[56:57], s[60:61]
  s_cselect_b32 s56, 1, 0
  s_mov_b64 exec, 1
  v_mov_b32 v156, 159960
  v_mov_b32 v157, s56
  ds_write_b32 v156, v157
  s_mov_b64 exec, -1
L_w4_14:
  ds_read_b128 v[80:83], v98 offset:49152
  ds_read_b64_tr_b16 v[88:89], v100 offset:4096
  ds_read_b64_tr_b16 v[90:91], v100 offset:4608
  s_waitcnt lgkmcnt(3)
  v_mfma_f32_32x32x16_bf16 v[64:79], v[92:95], v[84:87], v[64:79]
  ds_read_b128 v[84:87], v99 offset:49152
  ds_read_b64_tr_b16 v[92:93], v100 offset:6144
  ds_read_b64_tr_b16 v[94:95], v100 offset:6656
  s_waitcnt lgkmcnt(3)
  v_mfma_f32_32x32x16_bf16 v[64:79], v[88:91], v[80:83], v[64:79]
  s_waitcnt lgkmcnt(0)
  s_barrier
  ds_read_b128 v[80:83], v96 offset:57344
  ds_read_b64_tr_b16 v[88:89], v100 offset:24576
  ds_read_b64_tr_b16 v[90:91], v100 offset:25088
  v_mfma_f32_32x32x16_bf16 v[64:79], v[92:95], v[84:87], v[64:79]
  v_mov_b32 v4, 159956
  ds_read_b32 v5, v4
  s_waitcnt lgkmcnt(0)
  v_readfirstlane_b32 s42, v5
  v_mov_b32 v4, 159960
  ds_read_b32 v5, v4
  s_waitcnt lgkmcnt(0)
  v_readfirstlane_b32 s54, v5
  s_lshl_b32 s48, s43, 1
  s_and_b32 s49, s41, 1
  s_add_u32 s48, s48, s49
  s_lshl_b32 s48, s48, 10
  s_lshl_b32 s49, s44, 1
  s_lshr_b32 s50, s41, 1
  s_add_u32 s49, s49, s50
  s_lshl_b32 s49, s49, 17
  s_add_u32 s48, s48, s49
  s_add_u32 s49, s48, 0
  s_add_u32 s50, s48, 65536
  s_add_u32 s51, s48, 2097152
  s_add_u32 s52, s48, 2162688
  s_add_u32 s53, s48, 4194304
  ds_read_b128 v[84:87], v97 offset:57344
  ds_read_b64_tr_b16 v[92:93], v100 offset:26624
  ds_read_b64_tr_b16 v[94:95], v100 offset:27136
  s_waitcnt lgkmcnt(3)
  v_mfma_f32_32x32x16_bf16 v[64:79], v[88:91], v[80:83], v[64:79]
  ds_read_b128 v[80:83], v98 offset:57344
  ds_read_b64_tr_b16 v[88:89], v100 offset:28672
  ds_read_b64_tr_b16 v[90:91], v100 offset:29184
  s_waitcnt lgkmcnt(3)
  v_mfma_f32_32x32x16_bf16 v[64:79], v[92:95], v[84:87], v[64:79]
  ds_read_b128 v[84:87], v99 offset:57344
  ds_read_b64_tr_b16 v[92:93], v100 offset:30720
  ds_read_b64_tr_b16 v[94:95], v100 offset:31232
  s_waitcnt lgkmcnt(3)
  v_mfma_f32_32x32x16_bf16 v[64:79], v[88:91], v[80:83], v[64:79]
  s_waitcnt lgkmcnt(0)
  v_mfma_f32_32x32x16_bf16 v[64:79], v[92:95], v[84:87], v[64:79]
  s_waitcnt vmcnt(0)
  s_nop 10
  v_mul_f32 v64, 1052289595, v64
  v_mul_f32 v65, 1052289595, v65
  v_mul_f32 v66, 1052289595, v66
  v_mul_f32 v67, 1052289595, v67
  v_mul_f32 v68, 1052289595, v68
  v_mul_f32 v69, 1052289595, v69
  v_mul_f32 v70, 1052289595, v70
  v_mul_f32 v71, 1052289595, v71
  v_mul_f32 v72, 1052289595, v72
  v_mul_f32 v73, 1052289595, v73
  v_mul_f32 v74, 1052289595, v74
  v_mul_f32 v75, 1052289595, v75
  v_mul_f32 v76, 1052289595, v76
  v_mul_f32 v77, 1052289595, v77
  v_mul_f32 v78, 1052289595, v78
  v_mul_f32 v79, 1052289595, v79
  v_cvt_pk_bf16_f32 v112, v64, v65
  v_cvt_pk_bf16_f32 v113, v66, v67
  v_cvt_pk_bf16_f32 v114, v68, v69
  v_cvt_pk_bf16_f32 v115, v70, v71
  v_cvt_pk_bf16_f32 v116, v72, v73
  v_cvt_pk_bf16_f32 v117, v74, v75
  v_cvt_pk_bf16_f32 v118, v76, v77
  v_cvt_pk_bf16_f32 v119, v78, v79
  s_cmp_eq_u32 s54, 0
  s_cbranch_scc1 L_slow_15
  buffer_store_dwordx4 v[112:115], v1, s[20:23], s49 offen
  buffer_store_dwordx4 v[116:119], v1, s[20:23], s50 offen
  s_branch L_join_16
L_slow_15:
  buffer_store_dwordx4 v[112:115], v1, s[20:23], s49 offen sc1
  buffer_store_dwordx4 v[116:119], v1, s[20:23], s50 offen sc1
L_join_16:
  s_mov_b64 exec, 1
  v_mov_b32 v4, 159984
  v_mov_b32 v5, 1
  ds_add_u32 v4, v5
  s_mov_b64 exec, -1
  ds_read_b64_tr_b16 v[56:57], v8 offset:0
  ds_read_b64_tr_b16 v[58:59], v8 offset:128
  ds_read_b64_tr_b16 v[60:61], v8 offset:512
  ds_read_b64_tr_b16 v[62:63], v8 offset:640
  s_waitcnt lgkmcnt(0)
  v_mfma_f32_32x32x16_bf16 v[64:79], v[56:59], v[16:19], 0
  v_mfma_f32_32x32x16_bf16 v[80:95], v[56:59], v[24:27], 0
  v_mfma_f32_32x32x16_bf16 v[64:79], v[60:63], v[20:23], v[64:79]
  v_mfma_f32_32x32x16_bf16 v[80:95], v[60:63], v[28:31], v[80:95]
  s_nop 10
  v_pk_mul_f32 v[10:11], v[64:65], v[40:41]
  v_pk_mul_f32 v[12:13], v[80:81], v[40:41]
  v_pk_fma_f32 v[10:11], v[80:81], v[48:49], v[10:11]
  v_pk_fma_f32 v[12:13], v[64:65], v[48:49], v[12:13] neg_lo:[0,1,0] neg_hi:[0,1,0]
  v_cvt_pk_bf16_f32 v96, v10, v11
  v_cvt_pk_bf16_f32 v104, v12, v13
  v_pk_mul_f32 v[10:11], v[66:67], v[42:43]
  v_pk_mul_f32 v[12:13], v[82:83], v[42:43]
  v_pk_fma_f32 v[10:11], v[82:83], v[50:51], v[10:11]
  v_pk_fma_f32 v[12:13], v[66:67], v[50:51], v[12:13] neg_lo:[0,1,0] neg_hi:[0,1,0]
  v_cvt_pk_bf16_f32 v97, v10, v11
  v_cvt_pk_bf16_f32 v105, v12, v13
  v_pk_mul_f32 v[10:11], v[68:69], v[44:45]
  v_pk_mul_f32 v[12:13], v[84:85], v[44:45]
  v_pk_fma_f32 v[10:11], v[84:85], v[52:53], v[10:11]
  v_pk_fma_f32 v[12:13], v[68:69], v[52:53], v[12:13] neg_lo:[0,1,0] neg_hi:[0,1,0]
  v_cvt_pk_bf16_f32 v98, v10, v11
  v_cvt_pk_bf16_f32 v106, v12, v13
  v_pk_mul_f32 v[10:11], v[70:71], v[46:47]
  v_pk_mul_f32 v[12:13], v[86:87], v[46:47]
  v_pk_fma_f32 v[10:11], v[86:87], v[54:55], v[10:11]
  v_pk_fma_f32 v[12:13], v[70:71], v[54:55], v[12:13] neg_lo:[0,1,0] neg_hi:[0,1,0]
  v_cvt_pk_bf16_f32 v99, v10, v11
  v_cvt_pk_bf16_f32 v107, v12, v13
  v_pk_mul_f32 v[10:11], v[72:73], v[40:41]
  v_pk_mul_f32 v[12:13], v[88:89], v[40:41]
  v_pk_fma_f32 v[10:11], v[88:89], v[48:49], v[10:11]
  v_pk_fma_f32 v[12:13], v[72:73], v[48:49], v[12:13] neg_lo:[0,1,0] neg_hi:[0,1,0]
  v_cvt_pk_bf16_f32 v100, v10, v11
  v_cvt_pk_bf16_f32 v108, v12, v13
  v_pk_mul_f32 v[10:11], v[74:75], v[42:43]
  v_pk_mul_f32 v[12:13], v[90:91], v[42:43]
  v_pk_fma_f32 v[10:11], v[90:91], v[50:51], v[10:11]
  v_pk_fma_f32 v[12:13], v[74:75], v[50:51], v[12:13] neg_lo:[0,1,0] neg_hi:[0,1,0]
  v_cvt_pk_bf16_f32 v101, v10, v11
  v_cvt_pk_bf16_f32 v109, v12, v13
  v_pk_mul_f32 v[10:11], v[76:77], v[44:45]
  v_pk_mul_f32 v[12:13], v[92:93], v[44:45]
  v_pk_fma_f32 v[10:11], v[92:93], v[52:53], v[10:11]
  v_pk_fma_f32 v[12:13], v[76:77], v[52:53], v[12:13] neg_lo:[0,1,0] neg_hi:[0,1,0]
  v_cvt_pk_bf16_f32 v102, v10, v11
  v_cvt_pk_bf16_f32 v110, v12, v13
  v_pk_mul_f32 v[10:11], v[78:79], v[46:47]
  v_pk_mul_f32 v[12:13], v[94:95], v[46:47]
  v_pk_fma_f32 v[10:11], v[94:95], v[54:55], v[10:11]
  v_pk_fma_f32 v[12:13], v[78:79], v[54:55], v[12:13] neg_lo:[0,1,0] neg_hi:[0,1,0]
  v_cvt_pk_bf16_f32 v103, v10, v11
  v_cvt_pk_bf16_f32 v111, v12, v13
  s_waitcnt vmcnt(0)
  s_mov_b64 exec, 1
  v_mov_b32 v4, 159940
  v_mov_b32 v5, 1
  ds_add_rtn_u32 v5, v4, v5
  s_waitcnt lgkmcnt(0)
  v_readfirstlane_b32 s70, v5
  s_nop 0
  s_cmp_lg_u32 s70, 3
  s_cbranch_scc1 L_arr_17
  s_lshl_b32 s48, s44, 7
  s_lshl_b32 s55, s43, 2
  s_add_u32 s48, s48, s55
  s_add_u32 s48, s48, 17563648
  v_mov_b32 v6, 0
  v_mov_b32 v7, s42
  s_cmp_eq_u32 s54, 0
  s_cbranch_scc1 L_slow_18
  buffer_store_dword v7, v6, s[20:23], s48 offen
  s_branch L_join_19
L_slow_18:
  buffer_store_dword v7, v6, s[20:23], s48 offen sc1
L_join_19:
L_arr_17:
  s_mov_b64 exec, -1
  v_mfma_f32_32x32x16_bf16 v[64:79], v[32:35], v[96:99], 0
  v_mfma_f32_32x32x16_bf16 v[80:95], v[32:35], v[100:103], 0
  v_mfma_f32_32x32x16_bf16 v[64:79], v[36:39], v[104:107], v[64:79]
  v_mfma_f32_32x32x16_bf16 v[80:95], v[36:39], v[108:111], v[80:95]
  s_nop 7
  s_nop 3
  s_mov_b64 exec, 1
  v_mov_b32 v65, v72
  v_mov_b32 v81, v88
  s_mov_b64 exec, -1
  v_cvt_pk_bf16_f32 v10, v64, v80
  ds_write_b32 v9, v10 offset:0
  v_cvt_pk_bf16_f32 v11, v65, v81
  ds_write_b32 v9, v11 offset:16
  v_cvt_pk_bf16_f32 v10, v66, v82
  ds_write_b32 v9, v10 offset:1088
  v_cvt_pk_bf16_f32 v11, v67, v83
  ds_write_b32 v9, v11 offset:1104
  v_cvt_pk_bf16_f32 v10, v68, v84
  ds_write_b32 v9, v10 offset:4352
  v_cvt_pk_bf16_f32 v11, v69, v85
  ds_write_b32 v9, v11 offset:4368
  v_cvt_pk_bf16_f32 v10, v70, v86
  ds_write_b32 v9, v10 offset:5440
  v_cvt_pk_bf16_f32 v11, v71, v87
  ds_write_b32 v9, v11 offset:5456
  s_waitcnt lgkmcnt(0)
  s_mov_b64 exec, 1
  v_mov_b32 v4, 159984
  v_mov_b32 v5, 1
  ds_add_u32 v4, v5
  s_mov_b64 exec, -1
  s_and_b32 s60, s2, 7
  s_lshl_b32 s60, s60, 2
  s_bfe_u32 s61, s2, 0x20003
  s_add_u32 s60, s60, s61
  s_lshr_b32 s61, s2, 5
  s_lshl_b32 s61, s61, 3
  s_add_u32 s61, s61, s40
  s_lshl_b32 s53, s60, 16
  s_lshr_b32 s62, s40, 1
  s_and_b32 s63, s40, 1
  s_lshl_b32 s51, s62, 10
  s_lshl_b32 s64, s63, 9
  s_add_u32 s51, s51, s64
  s_lshl_b32 s52, s62, 11
  s_lshl_b32 s64, s63, 10
  s_add_u32 s52, s52, s64
  s_add_u32 s52, s52, 69632
  s_add_u32 s48, s53, s51
  s_add_u32 s49, s48, 4194304
  s_add_u32 s48, s48, 2097152
  s_add_u32 s51, s51, 65536
  s_lshl_b32 s64, s61, 10
  s_add_u32 s54, s53, s64
  s_add_u32 s54, s54, 0
  s_lshl_b32 s64, s61, 15
  s_lshl_b32 s65, s60, 10
  s_add_u32 s55, s64, s65
  s_add_u32 s55, s55, 6291456
  s_lshr_b32 s64, s60, 2
  s_lshl_b32 s64, s64, 7
  s_add_u32 s59, s64, 17564672
  s_lshr_b32 s65, s2, 5
  s_lshl_b32 s65, s65, 4
  s_add_u32 s56, s64, s65
  s_add_u32 s56, s56, 17563648
  s_mul_i32 s64, s61, 4352
  s_lshl_b32 s65, s60, 2
  s_add_u32 s57, s64, s65
  s_add_u32 s57, s57, 17825792
  s_mov_b32 s58, 0x7ff00000
  s_mov_b32 s60, 0xffff
  s_mov_b32 s61, 0xffff
  s_mov_b32 s62, -1
  s_mov_b32 s63, 0
  s_mov_b32 s50, 0
  s_add_u32 s48, s48, 8192
  s_add_u32 s49, s49, 8192
  s_mov_b32 s50, 2
  v_mov_b32 v4, 160012
L_lw_20:
  ds_read_b32 v5, v4
  s_waitcnt lgkmcnt(0)
  v_readfirstlane_b32 s70, v5
  s_nop 0
  s_cmp_ge_u32 s70, 1
  s_cbranch_scc1 L_lwok_21
  s_add_u32 s71, s71, 1
  s_cmp_gt_u32 s71, 131072
  s_cbranch_scc1 L_lwok_21
  s_branch L_lw_20
L_lwok_21:
  buffer_load_dwordx4 v[4:7], v1, s[20:23], s54 offen sc1
  s_branch L_att_entry2
L_att_entry:
  s_and_b32 s60, s2, 7
  s_lshl_b32 s60, s60, 2
  s_bfe_u32 s61, s2, 0x20003
  s_add_u32 s60, s60, s61
  s_lshr_b32 s61, s2, 5
  s_lshl_b32 s61, s61, 3
  s_add_u32 s61, s61, s40
  s_lshl_b32 s53, s60, 16
  s_lshr_b32 s62, s40, 1
  s_and_b32 s63, s40, 1
  s_lshl_b32 s51, s62, 10
  s_lshl_b32 s64, s63, 9
  s_add_u32 s51, s51, s64
  s_lshl_b32 s52, s62, 11
  s_lshl_b32 s64, s63, 10
  s_add_u32 s52, s52, s64
  s_add_u32 s52, s52, 69632
  s_add_u32 s48, s53, s51
  s_add_u32 s49, s48, 4194304
  s_add_u32 s48, s48, 2097152
  s_add_u32 s51, s51, 65536
  s_lshl_b32 s64, s61, 10
  s_add_u32 s54, s53, s64
  s_add_u32 s54, s54, 0
  s_lshl_b32 s64, s61, 15
  s_lshl_b32 s65, s60, 10
  s_add_u32 s55, s64, s65
  s_add_u32 s55, s55, 6291456
  s_lshr_b32 s64, s60, 2
  s_lshl_b32 s64, s64, 7
  s_add_u32 s59, s64, 17564672
  s_lshr_b32 s65, s2, 5
  s_lshl_b32 s65, s65, 4
  s_add_u32 s56, s64, s65
  s_add_u32 s56, s56, 17563648
  s_mul_i32 s64, s61, 4352
  s_lshl_b32 s65, s60, 2
  s_add_u32 s57, s64, s65
  s_add_u32 s57, s57, 17825792
  s_mov_b32 s58, 0x7ff00000
  s_mov_b32 s60, 0xffff
  s_mov_b32 s61, 0xffff
  s_mov_b32 s62, -1
  s_mov_b32 s63, 0
  s_mov_b32 s50, 0
  v_lshrrev_b32 v94, 5, v3
  v_lshlrev_b32 v94, 8, v94
  v_and_b32 v95, 15, v3
  v_lshl_add_u32 v94, v95, 4, v94
  s_cmp_lg_u32 s40, 0
  s_cbranch_scc1 L_ow_22
  s_mov_b32 exec_lo, -1
  s_mov_b32 exec_hi, 0xf
  v_lshlrev_b32 v104, 2, v3
  s_sub_u32 s67, s59, 0x400
  s_sub_u32 s66, s56, s67
  s_sub_u32 s66, s66, 128
  v_mov_b32 v105, s66
  v_add_u32 v105, v104, v105
  v_add_u32 v104, 0x400, v104
  v_cmp_le_u32 vcc, 32, v3
  s_nop 1
  v_cndmask_b32 v104, v104, v105, vcc
L_pk_24:
  buffer_load_dword v105, v104, s[20:23], s67 offen sc1
  s_waitcnt vmcnt(0)
  v_cmp_ne_u32 vcc, s42, v105
  s_nop 1
  s_cbranch_vccz L_pkok_25
  s_add_u32 s71, s71, 1
  s_cmp_gt_u32 s71, 131072
  s_cbranch_scc1 L_pkok_25
  s_sleep 1
  s_branch L_pk_24
L_pkok_25:
  s_mov_b64 exec, -1
  s_mov_b64 exec, 1
  v_mov_b32 v104, 160012
  v_mov_b32 v105, 1
  ds_write_b32 v104, v105
  s_mov_b64 exec, -1
  s_branch L_owd_23
L_ow_22:
  v_mov_b32 v104, 160012
L_lw_26:
  ds_read_b32 v105, v104
  s_waitcnt lgkmcnt(0)
  v_readfirstlane_b32 s70, v105
  s_nop 0
  s_cmp_ge_u32 s70, 1
  s_cbranch_scc1 L_lwok_27
  s_add_u32 s71, s71, 1
  s_cmp_gt_u32 s71, 131072
  s_cbranch_scc1 L_lwok_27
  s_sleep 1
  s_branch L_lw_26
L_lwok_27:
L_owd_23:
  buffer_load_dwordx4 v[4:7], v1, s[20:23], s54 offen sc1
  s_add_u32 s66, s48, 2048
  s_add_u32 s67, s49, 2048
  s_add_u32 s68, s52, 4096
  s_add_u32 m0, s51, 2048
  s_mov_b64 exec, s[62:63]
  buffer_load_dwordx4 v1, s[20:23], s66 offen sc1 lds
  s_mov_b32 m0, s68
  s_mov_b64 exec, s[60:61]
  buffer_load_dwordx4 v94, s[20:23], s67 offen sc1 lds
  s_mov_b64 exec, -1
  s_add_u32 s68, s52, 0
  s_add_u32 m0, s51, 0
  s_mov_b64 exec, s[62:63]
  buffer_load_dwordx4 v1, s[20:23], s48 offen sc1 lds
  s_mov_b32 m0, s68
  s_mov_b64 exec, s[60:61]
  buffer_load_dwordx4 v94, s[20:23], s49 offen sc1 lds
  s_mov_b64 exec, -1
  s_add_u32 s48, s48, 4096
  s_add_u32 s49, s49, 4096
  s_add_u32 s50, s50, 1
  s_add_u32 s66, s48, 2048
  s_add_u32 s67, s49, 2048
  s_add_u32 s68, s52, 16384
  s_add_u32 m0, s51, 14336
  s_mov_b64 exec, s[62:63]
  buffer_load_dwordx4 v1, s[20:23], s66 offen sc1 lds
  s_mov_b32 m0, s68
  s_mov_b64 exec, s[60:61]
  buffer_load_dwordx4 v94, s[20:23], s67 offen sc1 lds
  s_mov_b64 exec, -1
  s_add_u32 s68, s52, 12288
  s_add_u32 m0, s51, 12288
  s_mov_b64 exec, s[62:63]
  buffer_load_dwordx4 v1, s[20:23], s48 offen sc1 lds
  s_mov_b32 m0, s68
  s_mov_b64 exec, s[60:61]
  buffer_load_dwordx4 v94, s[20:23], s49 offen sc1 lds
  s_mov_b64 exec, -1
  s_add_u32 s48, s48, 4096
  s_add_u32 s49, s49, 4096
  s_add_u32 s50, s50, 1
L_att_entry2:
  v_lshrrev_b32 v94, 5, v3
  v_lshlrev_b32 v94, 8, v94
  v_and_b32 v95, 15, v3
  v_lshl_add_u32 v94, v95, 4, v94
  v_and_b32 v95, 27, v3
  v_cmp_eq_u32 vcc, 16, v95
  v_mov_b32 v88, 0x3f803f80
  s_nop 0
  v_cndmask_b32 v100, 0, v88, vcc
  v_mov_b32 v101, v100
  v_mov_b32 v102, v100
  v_mov_b32 v103, v100
  v_add_u32 v95, s52, v1
  s_not_b64 exec, s[60:61]
  ds_write_b128 v95, v[100:103] offset:0
  ds_write_b128 v95, v[100:103] offset:12288
  s_mov_b64 exec, -1
  v_mov_b32 v96, 159936
  v_mov_b32 v97, 1
  s_mov_b32 s65, 0
  v_add_u32 v99, 65536, v1
  v_mov_b32 v24, 0
  v_mov_b32 v25, 0
  v_mov_b32 v26, 0
  v_mov_b32 v27, 0
  v_mov_b32 v28, 0
  v_mov_b32 v29, 0
  v_mov_b32 v30, 0
  v_mov_b32 v31, 0
  v_mov_b32 v64, 0
  v_mov_b32 v65, 0
  v_mov_b32 v66, 0
  v_mov_b32 v67, 0
  v_mov_b32 v68, 0
  v_mov_b32 v69, 0
  v_mov_b32 v70, 0
  v_mov_b32 v71, 0
  v_mov_b32 v72, 0
  v_mov_b32 v73, 0
  v_mov_b32 v74, 0
  v_mov_b32 v75, 0
  v_mov_b32 v76, 0
  v_mov_b32 v77, 0
  v_mov_b32 v78, 0
  v_mov_b32 v79, 0
  v_mov_b32 v80, 0
  v_mov_b32 v81, 0
  v_mov_b32 v82, 0
  v_mov_b32 v83, 0
  v_mov_b32 v84, 0
  v_mov_b32 v85, 0
  v_mov_b32 v86, 0
  v_mov_b32 v87, 0
  v_mov_b32 v88, 0
  v_mov_b32 v89, 0
  v_mov_b32 v90, 0
  v_mov_b32 v91, 0
  v_mov_b32 v92, 0
  v_mov_b32 v93, 0
  s_waitcnt vmcnt(0) lgkmcnt(0)
  s_mov_b64 exec, 1
  v_mov_b32 v104, 160000
  v_mov_b32 v105, 1
  ds_add_u32 v104, v105
  s_mov_b64 exec, -1
  v_mov_b32 v104, 160000
L_lw_28:
  ds_read_b32 v105, v104
  s_waitcnt lgkmcnt(0)
  v_readfirstlane_b32 s70, v105
  s_nop 0
  s_cmp_ge_u32 s70, 8
  s_cbranch_scc1 L_lwok_29
  s_add_u32 s71, s71, 1
  s_cmp_gt_u32 s71, 131072
  s_cbranch_scc1 L_lwok_29
  s_branch L_lw_28
L_lwok_29:
  s_add_u32 s68, s52, 24576
  s_add_u32 m0, s51, 24576
  s_mov_b64 exec, s[62:63]
  buffer_load_dwordx4 v1, s[20:23], s48 offen sc1 lds
  s_mov_b32 m0, s68
  s_mov_b64 exec, s[60:61]
  buffer_load_dwordx4 v94, s[20:23], s49 offen sc1 lds
  s_mov_b64 exec, -1
  s_add_u32 s48, s48, 4096
  s_add_u32 s49, s49, 4096
  s_add_u32 s50, s50, 1
  s_not_b64 exec, s[60:61]
  ds_write_b128 v95, v[100:103] offset:24576
  ds_write_b128 v95, v[100:103] offset:36864
  s_mov_b64 exec, -1
  ds_read_b128 v[8:11], v99 offset:0
  ds_read_b128 v[16:19], v99 offset:4096
  ds_read_b128 v[20:23], v99 offset:5120
  ds_read_b128 v[12:15], v99 offset:1024
  s_waitcnt lgkmcnt(3)
  v_mfma_f32_32x32x16_bf16 v[32:47], v[8:11], v[4:7], 0
  s_nop 7
  s_nop 3
  s_setprio 1
  s_waitcnt lgkmcnt(0)
  v_mfma_f32_32x32x16_bf16 v[48:63], v[12:15], v[4:7], 0
  v_cvt_pk_bf16_f32 v87, v90, v91
  v_exp_f32 v88, v32
  v_exp_f32 v89, v33
  v_exp_f32 v90, v34
  v_mfma_f32_32x32x16_bf16 v[64:79], v[28:31], v[84:87], v[64:79]
  v_exp_f32 v91, v35
  ds_read_b128 v[8:11], v99 offset:2048
  v_cvt_pk_bf16_f32 v80, v88, v89
  v_exp_f32 v92, v36
  ds_read_b128 v[24:27], v99 offset:6144
  v_cvt_pk_bf16_f32 v81, v90, v91
  v_exp_f32 v93, v37
  ds_read_b128 v[28:31], v99 offset:7168
  v_exp_f32 v88, v38
  s_waitcnt vmcnt(2)
  v_cvt_pk_bf16_f32 v82, v92, v93
  v_exp_f32 v89, v39
  s_mov_b64 exec, 1
  ds_add_u32 v96, v97
  s_mov_b64 exec, -1
  v_exp_f32 v90, v40
  s_add_u32 s65, s65, 8
  v_cvt_pk_bf16_f32 v83, v88, v89
  v_exp_f32 v91, v41
  v_exp_f32 v92, v42
  v_mfma_f32_32x32x16_bf16 v[64:79], v[16:19], v[80:83], v[64:79]
  v_cvt_pk_bf16_f32 v84, v90, v91
  v_exp_f32 v93, v43
  v_exp_f32 v88, v44
  v_cvt_pk_bf16_f32 v85, v92, v93
  v_exp_f32 v89, v45
  v_exp_f32 v90, v46
  v_cvt_pk_bf16_f32 v86, v88, v89
  v_exp_f32 v91, v47
  s_setprio 0
  s_waitcnt lgkmcnt(0)
  v_mfma_f32_32x32x16_bf16 v[32:47], v[8:11], v[4:7], 0
  v_cvt_pk_bf16_f32 v87, v90, v91
  v_exp_f32 v88, v48
  v_exp_f32 v89, v49
  v_exp_f32 v90, v50
  v_mfma_f32_32x32x16_bf16 v[64:79], v[20:23], v[84:87], v[64:79]
  v_exp_f32 v91, v51
  ds_read_b128 v[12:15], v99 offset:3072
  v_cvt_pk_bf16_f32 v80, v88, v89
  v_exp_f32 v92, v52
  ds_read_b128 v[16:19], v99 offset:8192
  v_cvt_pk_bf16_f32 v81, v90, v91
  v_exp_f32 v93, v53
  ds_read_b128 v[20:23], v99 offset:9216
  v_exp_f32 v88, v54
  ds_read_b32 v98, v96
  v_cvt_pk_bf16_f32 v82, v92, v93
  v_exp_f32 v89, v55
  v_exp_f32 v90, v56
  v_cvt_pk_bf16_f32 v83, v88, v89
  v_exp_f32 v91, v57
  v_exp_f32 v92, v58
  v_mfma_f32_32x32x16_bf16 v[64:79], v[24:27], v[80:83], v[64:79]
  v_cvt_pk_bf16_f32 v84, v90, v91
  v_exp_f32 v93, v59
  v_exp_f32 v88, v60
  v_cvt_pk_bf16_f32 v85, v92, v93
  v_exp_f32 v89, v61
  v_exp_f32 v90, v62
  v_cvt_pk_bf16_f32 v86, v88, v89
  v_exp_f32 v91, v63
  s_setprio 3
  s_waitcnt lgkmcnt(0)
  v_readfirstlane_b32 s70, v98
  s_nop 0
  s_cmp_ge_u32 s70, s65
  s_cbranch_scc1 L_go_31
L_spin_30:
  s_add_u32 s71, s71, 1
  s_cmp_gt_u32 s71, 131072
  s_cbranch_scc1 L_go_31
  ds_read_b32 v98, v96
  s_waitcnt lgkmcnt(0)
  v_readfirstlane_b32 s70, v98
  s_nop 0
  s_cmp_ge_u32 s70, s65
  s_cbranch_scc0 L_spin_30
L_go_31:
  v_mfma_f32_32x32x16_bf16 v[48:63], v[12:15], v[4:7], 0
  v_cvt_pk_bf16_f32 v87, v90, v91
  v_exp_f32 v88, v32
  v_exp_f32 v89, v33
  v_exp_f32 v90, v34
  v_mfma_f32_32x32x16_bf16 v[64:79], v[28:31], v[84:87], v[64:79]
  v_exp_f32 v91, v35
  ds_read_b128 v[8:11], v99 offset:12288
  v_cvt_pk_bf16_f32 v80, v88, v89
  v_exp_f32 v92, v36
  ds_read_b128 v[24:27], v99 offset:10240
  v_cvt_pk_bf16_f32 v81, v90, v91
  v_exp_f32 v93, v37
  ds_read_b128 v[28:31], v99 offset:11264
  v_exp_f32 v88, v38
  s_add_u32 s68, s52, 36864
  v_cvt_pk_bf16_f32 v82, v92, v93
  v_exp_f32 v89, v39
  s_add_u32 m0, s51, 36864
  s_mov_b64 exec, s[62:63]
  buffer_load_dwordx4 v1, s[20:23], s48 offen sc1 lds
  s_mov_b32 m0, s68
  s_mov_b64 exec, s[60:61]
  buffer_load_dwordx4 v94, s[20:23], s49 offen sc1 lds
  s_mov_b64 exec, -1
  v_exp_f32 v90, v40
  s_add_u32 s48, s48, 4096
  v_cvt_pk_bf16_f32 v83, v88, v89
  v_exp_f32 v91, v41
  s_add_u32 s49, s49, 4096
  v_exp_f32 v92, v42
  s_add_u32 s50, s50, 1
  v_mfma_f32_32x32x16_bf16 v[64:79], v[16:19], v[80:83], v[64:79]
  v_cvt_pk_bf16_f32 v84, v90, v91
  v_exp_f32 v93, v43
  v_exp_f32 v88, v44
  v_cvt_pk_bf16_f32 v85, v92, v93
  v_exp_f32 v89, v45
  v_exp_f32 v90, v46
  v_cvt_pk_bf16_f32 v86, v88, v89
  v_exp_f32 v91, v47
  s_setprio 2
  s_waitcnt lgkmcnt(0)
  v_mfma_f32_32x32x16_bf16 v[32:47], v[8:11], v[4:7], 0
  v_cvt_pk_bf16_f32 v87, v90, v91
  v_exp_f32 v88, v48
  v_exp_f32 v89, v49
  v_exp_f32 v90, v50
  v_mfma_f32_32x32x16_bf16 v[64:79], v[20:23], v[84:87], v[64:79]
  v_exp_f32 v91, v51
  ds_read_b128 v[12:15], v99 offset:13312
  v_cvt_pk_bf16_f32 v80, v88, v89
  v_exp_f32 v92, v52
  ds_read_b128 v[16:19], v99 offset:16384
  v_cvt_pk_bf16_f32 v81, v90, v91
  v_exp_f32 v93, v53
  ds_read_b128 v[20:23], v99 offset:17408
  v_exp_f32 v88, v54
  v_cvt_pk_bf16_f32 v82, v92, v93
  v_exp_f32 v89, v55
  v_exp_f32 v90, v56
  v_cvt_pk_bf16_f32 v83, v88, v89
  v_exp_f32 v91, v57
  v_exp_f32 v92, v58
  v_mfma_f32_32x32x16_bf16 v[64:79], v[24:27], v[80:83], v[64:79]
  v_cvt_pk_bf16_f32 v84, v90, v91
  v_exp_f32 v93, v59
  v_exp_f32 v88, v60
  v_cvt_pk_bf16_f32 v85, v92, v93
  v_exp_f32 v89, v61
  v_exp_f32 v90, v62
  v_cvt_pk_bf16_f32 v86, v88, v89
  v_exp_f32 v91, v63
  s_setprio 1
  s_waitcnt lgkmcnt(0)
  v_mfma_f32_32x32x16_bf16 v[48:63], v[12:15], v[4:7], 0
  v_cvt_pk_bf16_f32 v87, v90, v91
  v_exp_f32 v88, v32
  v_exp_f32 v89, v33
  v_exp_f32 v90, v34
  v_mfma_f32_32x32x16_bf16 v[64:79], v[28:31], v[84:87], v[64:79]
  v_exp_f32 v91, v35
  ds_read_b128 v[8:11], v99 offset:14336
  v_cvt_pk_bf16_f32 v80, v88, v89
  v_exp_f32 v92, v36
  ds_read_b128 v[24:27], v99 offset:18432
  v_cvt_pk_bf16_f32 v81, v90, v91
  v_exp_f32 v93, v37
  ds_read_b128 v[28:31], v99 offset:19456
  v_exp_f32 v88, v38
  s_waitcnt vmcnt(2)
  v_cvt_pk_bf16_f32 v82, v92, v93
  v_exp_f32 v89, v39
  s_mov_b64 exec, 1
  ds_add_u32 v96, v97
  s_mov_b64 exec, -1
  v_exp_f32 v90, v40
  s_add_u32 s65, s65, 8
  v_cvt_pk_bf16_f32 v83, v88, v89
  v_exp_f32 v91, v41
  v_exp_f32 v92, v42
  v_mfma_f32_32x32x16_bf16 v[64:79], v[16:19], v[80:83], v[64:79]
  v_cvt_pk_bf16_f32 v84, v90, v91
  v_exp_f32 v93, v43
  v_exp_f32 v88, v44
  v_cvt_pk_bf16_f32 v85, v92, v93
  v_exp_f32 v89, v45
  v_exp_f32 v90, v46
  v_cvt_pk_bf16_f32 v86, v88, v89
  v_exp_f32 v91, v47
  s_setprio 0
  s_waitcnt lgkmcnt(0)
  v_mfma_f32_32x32x16_bf16 v[32:47], v[8:11], v[4:7], 0
  v_cvt_pk_bf16_f32 v87, v90, v91
  v_exp_f32 v88, v48
  v_exp_f32 v89, v49
  v_exp_f32 v90, v50
  v_mfma_f32_32x32x16_bf16 v[64:79], v[20:23], v[84:87], v[64:79]
  v_exp_f32 v91, v51
  ds_read_b128 v[12:15], v99 offset:15360
  v_cvt_pk_bf16_f32 v80, v88, v89
  v_exp_f32 v92, v52
  ds_read_b128 v[16:19], v99 offset:20480
  v_cvt_pk_bf16_f32 v81, v90, v91
  v_exp_f32 v93, v53
  ds_read_b128 v[20:23], v99 offset:21504
  v_exp_f32 v88, v54
  ds_read_b32 v98, v96
  v_cvt_pk_bf16_f32 v82, v92, v93
  v_exp_f32 v89, v55
  v_exp_f32 v90, v56
  v_cvt_pk_bf16_f32 v83, v88, v89
  v_exp_f32 v91, v57
  v_exp_f32 v92, v58
  v_mfma_f32_32x32x16_bf16 v[64:79], v[24:27], v[80:83], v[64:79]
  v_cvt_pk_bf16_f32 v84, v90, v91
  v_exp_f32 v93, v59
  v_exp_f32 v88, v60
  v_cvt_pk_bf16_f32 v85, v92, v93
  v_exp_f32 v89, v61
  v_exp_f32 v90, v62
  v_cvt_pk_bf16_f32 v86, v88, v89
  v_exp_f32 v91, v63
  s_setprio 3
  s_waitcnt lgkmcnt(0)
  v_readfirstlane_b32 s70, v98
  s_nop 0
  s_cmp_ge_u32 s70, s65
  s_cbranch_scc1 L_go_33
L_spin_32:
  s_add_u32 s71, s71, 1
  s_cmp_gt_u32 s71, 131072
  s_cbranch_scc1 L_go_33
  ds_read_b32 v98, v96
  s_waitcnt lgkmcnt(0)
  v_readfirstlane_b32 s70, v98
  s_nop 0
  s_cmp_ge_u32 s70, s65
  s_cbranch_scc0 L_spin_32
L_go_33:
  v_mfma_f32_32x32x16_bf16 v[48:63], v[12:15], v[4:7], 0
  v_cvt_pk_bf16_f32 v87, v90, v91
  v_exp_f32 v88, v32
  v_exp_f32 v89, v33
  v_exp_f32 v90, v34
  v_mfma_f32_32x32x16_bf16 v[64:79], v[28:31], v[84:87], v[64:79]
  v_exp_f32 v91, v35
  ds_read_b128 v[8:11], v99 offset:24576
  v_cvt_pk_bf16_f32 v80, v88, v89
  v_exp_f32 v92, v36
  ds_read_b128 v[24:27], v99 offset:22528
  v_cvt_pk_bf16_f32 v81, v90, v91
  v_exp_f32 v93, v37
  ds_read_b128 v[28:31], v99 offset:23552
  v_exp_f32 v88, v38
  s_add_u32 s68, s52, 0
  v_cvt_pk_bf16_f32 v82, v92, v93
  v_exp_f32 v89, v39
  s_add_u32 m0, s51, 0
  s_mov_b64 exec, s[62:63]
  buffer_load_dwordx4 v1, s[20:23], s48 offen sc1 lds
  s_mov_b32 m0, s68
  s_mov_b64 exec, s[60:61]
  buffer_load_dwordx4 v94, s[20:23], s49 offen sc1 lds
  s_mov_b64 exec, -1
  v_exp_f32 v90, v40
  s_add_u32 s48, s48, 4096
  v_cvt_pk_bf16_f32 v83, v88, v89
  v_exp_f32 v91, v41
  s_add_u32 s49, s49, 4096
  v_exp_f32 v92, v42
  s_add_u32 s50, s50, 1
  v_mfma_f32_32x32x16_bf16 v[64:79], v[16:19], v[80:83], v[64:79]
  v_cvt_pk_bf16_f32 v84, v90, v91
  v_exp_f32 v93, v43
  v_exp_f32 v88, v44
  v_cvt_pk_bf16_f32 v85, v92, v93
  v_exp_f32 v89, v45
  v_exp_f32 v90, v46
  v_cvt_pk_bf16_f32 v86, v88, v89
  v_exp_f32 v91, v47
  s_setprio 2
  s_waitcnt lgkmcnt(0)
  v_mfma_f32_32x32x16_bf16 v[32:47], v[8:11], v[4:7], 0
  v_cvt_pk_bf16_f32 v87, v90, v91
  v_exp_f32 v88, v48
  v_exp_f32 v89, v49
  v_exp_f32 v90, v50
  v_mfma_f32_32x32x16_bf16 v[64:79], v[20:23], v[84:87], v[64:79]
  v_exp_f32 v91, v51
  ds_read_b128 v[12:15], v99 offset:25600
  v_cvt_pk_bf16_f32 v80, v88, v89
  v_exp_f32 v92, v52
  ds_read_b128 v[16:19], v99 offset:28672
  v_cvt_pk_bf16_f32 v81, v90, v91
  v_exp_f32 v93, v53
  ds_read_b128 v[20:23], v99 offset:29696
  v_exp_f32 v88, v54
  v_cvt_pk_bf16_f32 v82, v92, v93
  v_exp_f32 v89, v55
  v_exp_f32 v90, v56
  v_cvt_pk_bf16_f32 v83, v88, v89
  v_exp_f32 v91, v57
  v_exp_f32 v92, v58
  v_mfma_f32_32x32x16_bf16 v[64:79], v[24:27], v[80:83], v[64:79]
  v_cvt_pk_bf16_f32 v84, v90, v91
  v_exp_f32 v93, v59
  v_exp_f32 v88, v60
  v_cvt_pk_bf16_f32 v85, v92, v93
  v_exp_f32 v89, v61
  v_exp_f32 v90, v62
  v_cvt_pk_bf16_f32 v86, v88, v89
  v_exp_f32 v91, v63
  s_setprio 1
  s_waitcnt lgkmcnt(0)
  v_mfma_f32_32x32x16_bf16 v[48:63], v[12:15], v[4:7], 0
  v_cvt_pk_bf16_f32 v87, v90, v91
  v_exp_f32 v88, v32
  v_exp_f32 v89, v33
  v_exp_f32 v90, v34
  v_mfma_f32_32x32x16_bf16 v[64:79], v[28:31], v[84:87], v[64:79]
  v_exp_f32 v91, v35
  ds_read_b128 v[8:11], v99 offset:26624
  v_cvt_pk_bf16_f32 v80, v88, v89
  v_exp_f32 v92, v36
  ds_read_b128 v[24:27], v99 offset:30720
  v_cvt_pk_bf16_f32 v81, v90, v91
  v_exp_f32 v93, v37
  ds_read_b128 v[28:31], v99 offset:31744
  v_exp_f32 v88, v38
  s_waitcnt vmcnt(2)
  v_cvt_pk_bf16_f32 v82, v92, v93
  v_exp_f32 v89, v39
  s_mov_b64 exec, 1
  ds_add_u32 v96, v97
  s_mov_b64 exec, -1
  v_exp_f32 v90, v40
  s_add_u32 s65, s65, 8
  v_cvt_pk_bf16_f32 v83, v88, v89
  v_exp_f32 v91, v41
  v_exp_f32 v92, v42
  v_mfma_f32_32x32x16_bf16 v[64:79], v[16:19], v[80:83], v[64:79]
  v_cvt_pk_bf16_f32 v84, v90, v91
  v_exp_f32 v93, v43
  v_exp_f32 v88, v44
  v_cvt_pk_bf16_f32 v85, v92, v93
  v_exp_f32 v89, v45
  v_exp_f32 v90, v46
  v_cvt_pk_bf16_f32 v86, v88, v89
  v_exp_f32 v91, v47
  s_setprio 0
  s_waitcnt lgkmcnt(0)
  v_mfma_f32_32x32x16_bf16 v[32:47], v[8:11], v[4:7], 0
  v_cvt_pk_bf16_f32 v87, v90, v91
  v_exp_f32 v88, v48
  v_exp_f32 v89, v49
  v_exp_f32 v90, v50
  v_mfma_f32_32x32x16_bf16 v[64:79], v[20:23], v[84:87], v[64:79]
  v_exp_f32 v91, v51
  ds_read_b128 v[12:15], v99 offset:27648
  v_cvt_pk_bf16_f32 v80, v88, v89
  v_exp_f32 v92, v52
  ds_read_b128 v[16:19], v99 offset:32768
  v_cvt_pk_bf16_f32 v81, v90, v91
  v_exp_f32 v93, v53
  ds_read_b128 v[20:23], v99 offset:33792
  v_exp_f32 v88, v54
  ds_read_b32 v98, v96
  v_cvt_pk_bf16_f32 v82, v92, v93
  v_exp_f32 v89, v55
  v_exp_f32 v90, v56
  v_cvt_pk_bf16_f32 v83, v88, v89
  v_exp_f32 v91, v57
  v_exp_f32 v92, v58
  v_mfma_f32_32x32x16_bf16 v[64:79], v[24:27], v[80:83], v[64:79]
  v_cvt_pk_bf16_f32 v84, v90, v91
  v_exp_f32 v93, v59
  v_exp_f32 v88, v60
  v_cvt_pk_bf16_f32 v85, v92, v93
  v_exp_f32 v89, v61
  v_exp_f32 v90, v62
  v_cvt_pk_bf16_f32 v86, v88, v89
  v_exp_f32 v91, v63
  s_setprio 3
  s_waitcnt lgkmcnt(0)
  v_readfirstlane_b32 s70, v98
  s_nop 0
  s_cmp_ge_u32 s70, s65
  s_cbranch_scc1 L_go_35
L_spin_34:
  s_add_u32 s71, s71, 1
  s_cmp_gt_u32 s71, 131072
  s_cbranch_scc1 L_go_35
  ds_read_b32 v98, v96
  s_waitcnt lgkmcnt(0)
  v_readfirstlane_b32 s70, v98
  s_nop 0
  s_cmp_ge_u32 s70, s65
  s_cbranch_scc0 L_spin_34
L_go_35:
  v_mfma_f32_32x32x16_bf16 v[48:63], v[12:15], v[4:7], 0
  v_cvt_pk_bf16_f32 v87, v90, v91
  v_exp_f32 v88, v32
  v_exp_f32 v89, v33
  v_exp_f32 v90, v34
  v_mfma_f32_32x32x16_bf16 v[64:79], v[28:31], v[84:87], v[64:79]
  v_exp_f32 v91, v35
  ds_read_b128 v[8:11], v99 offset:36864
  v_cvt_pk_bf16_f32 v80, v88, v89
  v_exp_f32 v92, v36
  ds_read_b128 v[24:27], v99 offset:34816
  v_cvt_pk_bf16_f32 v81, v90, v91
  v_exp_f32 v93, v37
  ds_read_b128 v[28:31], v99 offset:35840
  v_exp_f32 v88, v38
  s_add_u32 s68, s52, 12288
  v_cvt_pk_bf16_f32 v82, v92, v93
  v_exp_f32 v89, v39
  s_add_u32 m0, s51, 12288
  s_mov_b64 exec, s[62:63]
  buffer_load_dwordx4 v1, s[20:23], s48 offen sc1 lds
  s_mov_b32 m0, s68
  s_mov_b64 exec, s[60:61]
  buffer_load_dwordx4 v94, s[20:23], s49 offen sc1 lds
  s_mov_b64 exec, -1
  v_exp_f32 v90, v40
  s_add_u32 s48, s48, 4096
  v_cvt_pk_bf16_f32 v83, v88, v89
  v_exp_f32 v91, v41
  s_add_u32 s49, s49, 4096
  v_exp_f32 v92, v42
  s_add_u32 s50, s50, 1
  v_mfma_f32_32x32x16_bf16 v[64:79], v[16:19], v[80:83], v[64:79]
  v_cvt_pk_bf16_f32 v84, v90, v91
  v_exp_f32 v93, v43
  v_exp_f32 v88, v44
  v_cvt_pk_bf16_f32 v85, v92, v93
  v_exp_f32 v89, v45
  v_exp_f32 v90, v46
  v_cvt_pk_bf16_f32 v86, v88, v89
  v_exp_f32 v91, v47
  s_setprio 2
  s_waitcnt lgkmcnt(0)
  v_mfma_f32_32x32x16_bf16 v[32:47], v[8:11], v[4:7], 0
  v_cvt_pk_bf16_f32 v87, v90, v91
  v_exp_f32 v88, v48
  v_exp_f32 v89, v49
  v_exp_f32 v90, v50
  v_mfma_f32_32x32x16_bf16 v[64:79], v[20:23], v[84:87], v[64:79]
  v_exp_f32 v91, v51
  ds_read_b128 v[12:15], v99 offset:37888
  v_cvt_pk_bf16_f32 v80, v88, v89
  v_exp_f32 v92, v52
  ds_read_b128 v[16:19], v99 offset:40960
  v_cvt_pk_bf16_f32 v81, v90, v91
  v_exp_f32 v93, v53
  ds_read_b128 v[20:23], v99 offset:41984
  v_exp_f32 v88, v54
  v_cvt_pk_bf16_f32 v82, v92, v93
  v_exp_f32 v89, v55
  v_exp_f32 v90, v56
  v_cvt_pk_bf16_f32 v83, v88, v89
  v_exp_f32 v91, v57
  v_exp_f32 v92, v58
  v_mfma_f32_32x32x16_bf16 v[64:79], v[24:27], v[80:83], v[64:79]
  v_cvt_pk_bf16_f32 v84, v90, v91
  v_exp_f32 v93, v59
  v_exp_f32 v88, v60
  v_cvt_pk_bf16_f32 v85, v92, v93
  v_exp_f32 v89, v61
  v_exp_f32 v90, v62
  v_cvt_pk_bf16_f32 v86, v88, v89
  v_exp_f32 v91, v63
  s_setprio 1
  s_waitcnt lgkmcnt(0)
  v_mfma_f32_32x32x16_bf16 v[48:63], v[12:15], v[4:7], 0
  v_cvt_pk_bf16_f32 v87, v90, v91
  v_exp_f32 v88, v32
  v_exp_f32 v89, v33
  v_exp_f32 v90, v34
  v_mfma_f32_32x32x16_bf16 v[64:79], v[28:31], v[84:87], v[64:79]
  v_exp_f32 v91, v35
  ds_read_b128 v[8:11], v99 offset:38912
  v_cvt_pk_bf16_f32 v80, v88, v89
  v_exp_f32 v92, v36
  ds_read_b128 v[24:27], v99 offset:43008
  v_cvt_pk_bf16_f32 v81, v90, v91
  v_exp_f32 v93, v37
  ds_read_b128 v[28:31], v99 offset:44032
  v_exp_f32 v88, v38
  s_waitcnt vmcnt(2)
  v_cvt_pk_bf16_f32 v82, v92, v93
  v_exp_f32 v89, v39
  s_mov_b64 exec, 1
  ds_add_u32 v96, v97
  s_mov_b64 exec, -1
  v_exp_f32 v90, v40
  s_add_u32 s65, s65, 8
  v_cvt_pk_bf16_f32 v83, v88, v89
  v_exp_f32 v91, v41
  v_exp_f32 v92, v42
  v_mfma_f32_32x32x16_bf16 v[64:79], v[16:19], v[80:83], v[64:79]
  v_cvt_pk_bf16_f32 v84, v90, v91
  v_exp_f32 v93, v43
  v_exp_f32 v88, v44
  v_cvt_pk_bf16_f32 v85, v92, v93
  v_exp_f32 v89, v45
  v_exp_f32 v90, v46
  v_cvt_pk_bf16_f32 v86, v88, v89
  v_exp_f32 v91, v47
  s_setprio 0
  s_waitcnt lgkmcnt(0)
  v_mfma_f32_32x32x16_bf16 v[32:47], v[8:11], v[4:7], 0
  v_cvt_pk_bf16_f32 v87, v90, v91
  v_exp_f32 v88, v48
  v_exp_f32 v89, v49
  v_exp_f32 v90, v50
  v_mfma_f32_32x32x16_bf16 v[64:79], v[20:23], v[84:87], v[64:79]
  v_exp_f32 v91, v51
  ds_read_b128 v[12:15], v99 offset:39936
  v_cvt_pk_bf16_f32 v80, v88, v89
  v_exp_f32 v92, v52
  ds_read_b128 v[16:19], v99 offset:45056
  v_cvt_pk_bf16_f32 v81, v90, v91
  v_exp_f32 v93, v53
  ds_read_b128 v[20:23], v99 offset:46080
  v_exp_f32 v88, v54
  ds_read_b32 v98, v96
  v_cvt_pk_bf16_f32 v82, v92, v93
  v_exp_f32 v89, v55
  v_exp_f32 v90, v56
  v_cvt_pk_bf16_f32 v83, v88, v89
  v_exp_f32 v91, v57
  v_exp_f32 v92, v58
  v_mfma_f32_32x32x16_bf16 v[64:79], v[24:27], v[80:83], v[64:79]
  v_cvt_pk_bf16_f32 v84, v90, v91
  v_exp_f32 v93, v59
  v_exp_f32 v88, v60
  v_cvt_pk_bf16_f32 v85, v92, v93
  v_exp_f32 v89, v61
  v_exp_f32 v90, v62
  v_cvt_pk_bf16_f32 v86, v88, v89
  v_exp_f32 v91, v63
  s_setprio 3
  s_waitcnt lgkmcnt(0)
  v_readfirstlane_b32 s70, v98
  s_nop 0
  s_cmp_ge_u32 s70, s65
  s_cbranch_scc1 L_go_37
L_spin_36:
  s_add_u32 s71, s71, 1
  s_cmp_gt_u32 s71, 131072
  s_cbranch_scc1 L_go_37
  ds_read_b32 v98, v96
  s_waitcnt lgkmcnt(0)
  v_readfirstlane_b32 s70, v98
  s_nop 0
  s_cmp_ge_u32 s70, s65
  s_cbranch_scc0 L_spin_36
L_go_37:
  v_mfma_f32_32x32x16_bf16 v[48:63], v[12:15], v[4:7], 0
  v_cvt_pk_bf16_f32 v87, v90, v91
  v_exp_f32 v88, v32
  v_exp_f32 v89, v33
  v_exp_f32 v90, v34
  v_mfma_f32_32x32x16_bf16 v[64:79], v[28:31], v[84:87], v[64:79]
  v_exp_f32 v91, v35
  ds_read_b128 v[8:11], v99 offset:0
  v_cvt_pk_bf16_f32 v80, v88, v89
  v_exp_f32 v92, v36
  ds_read_b128 v[24:27], v99 offset:47104
  v_cvt_pk_bf16_f32 v81, v90, v91
  v_exp_f32 v93, v37
  ds_read_b128 v[28:31], v99 offset:48128
  v_exp_f32 v88, v38
  s_add_u32 s68, s52, 24576
  v_cvt_pk_bf16_f32 v82, v92, v93
  v_exp_f32 v89, v39
  s_add_u32 m0, s51, 24576
  s_mov_b64 exec, s[62:63]
  buffer_load_dwordx4 v1, s[20:23], s48 offen sc1 lds
  s_mov_b32 m0, s68
  s_mov_b64 exec, s[60:61]
  buffer_load_dwordx4 v94, s[20:23], s49 offen sc1 lds
  s_mov_b64 exec, -1
  v_exp_f32 v90, v40
  s_add_u32 s48, s48, 4096
  v_cvt_pk_bf16_f32 v83, v88, v89
  v_exp_f32 v91, v41
  s_add_u32 s49, s49, 4096
  v_exp_f32 v92, v42
  s_add_u32 s50, s50, 1
  v_mfma_f32_32x32x16_bf16 v[64:79], v[16:19], v[80:83], v[64:79]
  v_cvt_pk_bf16_f32 v84, v90, v91
  v_exp_f32 v93, v43
  v_exp_f32 v88, v44
  v_cvt_pk_bf16_f32 v85, v92, v93
  v_exp_f32 v89, v45
  v_exp_f32 v90, v46
  v_cvt_pk_bf16_f32 v86, v88, v89
  v_exp_f32 v91, v47
  s_setprio 2
  s_waitcnt lgkmcnt(0)
  v_mfma_f32_32x32x16_bf16 v[32:47], v[8:11], v[4:7], 0
  v_cvt_pk_bf16_f32 v87, v90, v91
  v_exp_f32 v88, v48
  v_exp_f32 v89, v49
  v_exp_f32 v90, v50
  v_mfma_f32_32x32x16_bf16 v[64:79], v[20:23], v[84:87], v[64:79]
  v_exp_f32 v91, v51
  ds_read_b128 v[12:15], v99 offset:1024
  v_cvt_pk_bf16_f32 v80, v88, v89
  v_exp_f32 v92, v52
  ds_read_b128 v[16:19], v99 offset:4096
  v_cvt_pk_bf16_f32 v81, v90, v91
  v_exp_f32 v93, v53
  ds_read_b128 v[20:23], v99 offset:5120
  v_exp_f32 v88, v54
  v_cvt_pk_bf16_f32 v82, v92, v93
  v_exp_f32 v89, v55
  v_exp_f32 v90, v56
  v_cvt_pk_bf16_f32 v83, v88, v89
  v_exp_f32 v91, v57
  v_exp_f32 v92, v58
  v_mfma_f32_32x32x16_bf16 v[64:79], v[24:27], v[80:83], v[64:79]
  v_cvt_pk_bf16_f32 v84, v90, v91
  v_exp_f32 v93, v59
  v_exp_f32 v88, v60
  v_cvt_pk_bf16_f32 v85, v92, v93
  v_exp_f32 v89, v61
  v_exp_f32 v90, v62
  v_cvt_pk_bf16_f32 v86, v88, v89
  v_exp_f32 v91, v63
  s_mov_b32 s64, 3
L_att_loop:
  s_setprio 1
  s_waitcnt lgkmcnt(0)
  v_mfma_f32_32x32x16_bf16 v[48:63], v[12:15], v[4:7], 0
  v_cvt_pk_bf16_f32 v87, v90, v91
  v_exp_f32 v88, v32
  v_exp_f32 v89, v33
  v_exp_f32 v90, v34
  v_mfma_f32_32x32x16_bf16 v[64:79], v[28:31], v[84:87], v[64:79]
  v_exp_f32 v91, v35
  ds_read_b128 v[8:11], v99 offset:2048
  v_cvt_pk_bf16_f32 v80, v88, v89
  v_exp_f32 v92, v36
  ds_read_b128 v[24:27], v99 offset:6144
  v_cvt_pk_bf16_f32 v81, v90, v91
  v_exp_f32 v93, v37
  ds_read_b128 v[28:31], v99 offset:7168
  v_exp_f32 v88, v38
  s_waitcnt vmcnt(2)
  v_cvt_pk_bf16_f32 v82, v92, v93
  v_exp_f32 v89, v39
  s_mov_b64 exec, 1
  ds_add_u32 v96, v97
  s_mov_b64 exec, -1
  v_exp_f32 v90, v40
  s_add_u32 s65, s65, 8
  v_cvt_pk_bf16_f32 v83, v88, v89
  v_exp_f32 v91, v41
  v_exp_f32 v92, v42
  v_mfma_f32_32x32x16_bf16 v[64:79], v[16:19], v[80:83], v[64:79]
  v_cvt_pk_bf16_f32 v84, v90, v91
  v_exp_f32 v93, v43
  v_exp_f32 v88, v44
  v_cvt_pk_bf16_f32 v85, v92, v93
  v_exp_f32 v89, v45
  v_exp_f32 v90, v46
  v_cvt_pk_bf16_f32 v86, v88, v89
  v_exp_f32 v91, v47
  s_setprio 0
  s_waitcnt lgkmcnt(0)
  v_mfma_f32_32x32x16_bf16 v[32:47], v[8:11], v[4:7], 0
  v_cvt_pk_bf16_f32 v87, v90, v91
  v_exp_f32 v88, v48
  v_exp_f32 v89, v49
  v_exp_f32 v90, v50
  v_mfma_f32_32x32x16_bf16 v[64:79], v[20:23], v[84:87], v[64:79]
  v_exp_f32 v91, v51
  ds_read_b128 v[12:15], v99 offset:3072
  v_cvt_pk_bf16_f32 v80, v88, v89
  v_exp_f32 v92, v52
  ds_read_b128 v[16:19], v99 offset:8192
  v_cvt_pk_bf16_f32 v81, v90, v91
  v_exp_f32 v93, v53
  ds_read_b128 v[20:23], v99 offset:9216
  v_exp_f32 v88, v54
  ds_read_b32 v98, v96
  v_cvt_pk_bf16_f32 v82, v92, v93
  v_exp_f32 v89, v55
  v_exp_f32 v90, v56
  v_cvt_pk_bf16_f32 v83, v88, v89
  v_exp_f32 v91, v57
  v_exp_f32 v92, v58
  v_mfma_f32_32x32x16_bf16 v[64:79], v[24:27], v[80:83], v[64:79]
  v_cvt_pk_bf16_f32 v84, v90, v91
  v_exp_f32 v93, v59
  v_exp_f32 v88, v60
  v_cvt_pk_bf16_f32 v85, v92, v93
  v_exp_f32 v89, v61
  v_exp_f32 v90, v62
  v_cvt_pk_bf16_f32 v86, v88, v89
  v_exp_f32 v91, v63
  s_setprio 3
  s_waitcnt lgkmcnt(0)
  v_readfirstlane_b32 s70, v98
  s_nop 0
  s_cmp_ge_u32 s70, s65
  s_cbranch_scc1 L_go_39
L_spin_38:
  s_add_u32 s71, s71, 1
  s_cmp_gt_u32 s71, 131072
  s_cbranch_scc1 L_go_39
  ds_read_b32 v98, v96
  s_waitcnt lgkmcnt(0)
  v_readfirstlane_b32 s70, v98
  s_nop 0
  s_cmp_ge_u32 s70, s65
  s_cbranch_scc0 L_spin_38
L_go_39:
  v_mfma_f32_32x32x16_bf16 v[48:63], v[12:15], v[4:7], 0
  v_cvt_pk_bf16_f32 v87, v90, v91
  v_exp_f32 v88, v32
  v_exp_f32 v89, v33
  v_exp_f32 v90, v34
  v_mfma_f32_32x32x16_bf16 v[64:79], v[28:31], v[84:87], v[64:79]
  v_exp_f32 v91, v35
  ds_read_b128 v[8:11], v99 offset:12288
  v_cvt_pk_bf16_f32 v80, v88, v89
  v_exp_f32 v92, v36
  ds_read_b128 v[24:27], v99 offset:10240
  v_cvt_pk_bf16_f32 v81, v90, v91
  v_exp_f32 v93, v37
  ds_read_b128 v[28:31], v99 offset:11264
  v_exp_f32 v88, v38
  s_cmp_lt_u32 s50, 16
  v_cvt_pk_bf16_f32 v82, v92, v93
  v_exp_f32 v89, v39
  s_cselect_b32 s66, s48, s58
  v_exp_f32 v90, v40
  s_cselect_b32 s67, s49, s58
  v_cvt_pk_bf16_f32 v83, v88, v89
  v_exp_f32 v91, v41
  s_add_u32 s68, s52, 36864
  v_exp_f32 v92, v42
  s_add_u32 m0, s51, 36864
  s_mov_b64 exec, s[62:63]
  buffer_load_dwordx4 v1, s[20:23], s66 offen sc1 lds
  s_mov_b32 m0, s68
  s_mov_b64 exec, s[60:61]
  buffer_load_dwordx4 v94, s[20:23], s67 offen sc1 lds
  s_mov_b64 exec, -1
  v_mfma_f32_32x32x16_bf16 v[64:79], v[16:19], v[80:83], v[64:79]
  v_cvt_pk_bf16_f32 v84, v90, v91
  v_exp_f32 v93, v43
  s_add_u32 s48, s48, 4096
  v_exp_f32 v88, v44
  s_add_u32 s49, s49, 4096
  v_cvt_pk_bf16_f32 v85, v92, v93
  v_exp_f32 v89, v45
  s_add_u32 s50, s50, 1
  v_exp_f32 v90, v46
  v_cvt_pk_bf16_f32 v86, v88, v89
  v_exp_f32 v91, v47
  s_setprio 2
  s_waitcnt lgkmcnt(0)
  v_mfma_f32_32x32x16_bf16 v[32:47], v[8:11], v[4:7], 0
  v_cvt_pk_bf16_f32 v87, v90, v91
  v_exp_f32 v88, v48
  v_exp_f32 v89, v49
  v_exp_f32 v90, v50
  v_mfma_f32_32x32x16_bf16 v[64:79], v[20:23], v[84:87], v[64:79]
  v_exp_f32 v91, v51
  ds_read_b128 v[12:15], v99 offset:13312
  v_cvt_pk_bf16_f32 v80, v88, v89
  v_exp_f32 v92, v52
  ds_read_b128 v[16:19], v99 offset:16384
  v_cvt_pk_bf16_f32 v81, v90, v91
  v_exp_f32 v93, v53
  ds_read_b128 v[20:23], v99 offset:17408
  v_exp_f32 v88, v54
  v_cvt_pk_bf16_f32 v82, v92, v93
  v_exp_f32 v89, v55
  v_exp_f32 v90, v56
  v_cvt_pk_bf16_f32 v83, v88, v89
  v_exp_f32 v91, v57
  v_exp_f32 v92, v58
  v_mfma_f32_32x32x16_bf16 v[64:79], v[24:27], v[80:83], v[64:79]
  v_cvt_pk_bf16_f32 v84, v90, v91
  v_exp_f32 v93, v59
  v_exp_f32 v88, v60
  v_cvt_pk_bf16_f32 v85, v92, v93
  v_exp_f32 v89, v61
  v_exp_f32 v90, v62
  v_cvt_pk_bf16_f32 v86, v88, v89
  v_exp_f32 v91, v63
  s_setprio 1
  s_waitcnt lgkmcnt(0)
  v_mfma_f32_32x32x16_bf16 v[48:63], v[12:15], v[4:7], 0
  v_cvt_pk_bf16_f32 v87, v90, v91
  v_exp_f32 v88, v32
  v_exp_f32 v89, v33
  v_exp_f32 v90, v34
  v_mfma_f32_32x32x16_bf16 v[64:79], v[28:31], v[84:87], v[64:79]
  v_exp_f32 v91, v35
  ds_read_b128 v[8:11], v99 offset:14336
  v_cvt_pk_bf16_f32 v80, v88, v89
  v_exp_f32 v92, v36
  ds_read_b128 v[24:27], v99 offset:18432
  v_cvt_pk_bf16_f32 v81, v90, v91
  v_exp_f32 v93, v37
  ds_read_b128 v[28:31], v99 offset:19456
  v_exp_f32 v88, v38
  s_waitcnt vmcnt(2)
  v_cvt_pk_bf16_f32 v82, v92, v93
  v_exp_f32 v89, v39
  s_mov_b64 exec, 1
  ds_add_u32 v96, v97
  s_mov_b64 exec, -1
  v_exp_f32 v90, v40
  s_add_u32 s65, s65, 8
  v_cvt_pk_bf16_f32 v83, v88, v89
  v_exp_f32 v91, v41
  v_exp_f32 v92, v42
  v_mfma_f32_32x32x16_bf16 v[64:79], v[16:19], v[80:83], v[64:79]
  v_cvt_pk_bf16_f32 v84, v90, v91
  v_exp_f32 v93, v43
  v_exp_f32 v88, v44
  v_cvt_pk_bf16_f32 v85, v92, v93
  v_exp_f32 v89, v45
  v_exp_f32 v90, v46
  v_cvt_pk_bf16_f32 v86, v88, v89
  v_exp_f32 v91, v47
  s_setprio 0
  s_waitcnt lgkmcnt(0)
  v_mfma_f32_32x32x16_bf16 v[32:47], v[8:11], v[4:7], 0
  v_cvt_pk_bf16_f32 v87, v90, v91
  v_exp_f32 v88, v48
  v_exp_f32 v89, v49
  v_exp_f32 v90, v50
  v_mfma_f32_32x32x16_bf16 v[64:79], v[20:23], v[84:87], v[64:79]
  v_exp_f32 v91, v51
  ds_read_b128 v[12:15], v99 offset:15360
  v_cvt_pk_bf16_f32 v80, v88, v89
  v_exp_f32 v92, v52
  ds_read_b128 v[16:19], v99 offset:20480
  v_cvt_pk_bf16_f32 v81, v90, v91
  v_exp_f32 v93, v53
  ds_read_b128 v[20:23], v99 offset:21504
  v_exp_f32 v88, v54
  ds_read_b32 v98, v96
  v_cvt_pk_bf16_f32 v82, v92, v93
  v_exp_f32 v89, v55
  v_exp_f32 v90, v56
  v_cvt_pk_bf16_f32 v83, v88, v89
  v_exp_f32 v91, v57
  v_exp_f32 v92, v58
  v_mfma_f32_32x32x16_bf16 v[64:79], v[24:27], v[80:83], v[64:79]
  v_cvt_pk_bf16_f32 v84, v90, v91
  v_exp_f32 v93, v59
  v_exp_f32 v88, v60
  v_cvt_pk_bf16_f32 v85, v92, v93
  v_exp_f32 v89, v61
  v_exp_f32 v90, v62
  v_cvt_pk_bf16_f32 v86, v88, v89
  v_exp_f32 v91, v63
  s_setprio 3
  s_waitcnt lgkmcnt(0)
  v_readfirstlane_b32 s70, v98
  s_nop 0
  s_cmp_ge_u32 s70, s65
  s_cbranch_scc1 L_go_41
L_spin_40:
  s_add_u32 s71, s71, 1
  s_cmp_gt_u32 s71, 131072
  s_cbranch_scc1 L_go_41
  ds_read_b32 v98, v96
  s_waitcnt lgkmcnt(0)
  v_readfirstlane_b32 s70, v98
  s_nop 0
  s_cmp_ge_u32 s70, s65
  s_cbranch_scc0 L_spin_40
L_go_41:
  v_mfma_f32_32x32x16_bf16 v[48:63], v[12:15], v[4:7], 0
  v_cvt_pk_bf16_f32 v87, v90, v91
  v_exp_f32 v88, v32
  v_exp_f32 v89, v33
  v_exp_f32 v90, v34
  v_mfma_f32_32x32x16_bf16 v[64:79], v[28:31], v[84:87], v[64:79]
  v_exp_f32 v91, v35
  ds_read_b128 v[8:11], v99 offset:24576
  v_cvt_pk_bf16_f32 v80, v88, v89
  v_exp_f32 v92, v36
  ds_read_b128 v[24:27], v99 offset:22528
  v_cvt_pk_bf16_f32 v81, v90, v91
  v_exp_f32 v93, v37
  ds_read_b128 v[28:31], v99 offset:23552
  v_exp_f32 v88, v38
  s_cmp_lt_u32 s50, 16
  v_cvt_pk_bf16_f32 v82, v92, v93
  v_exp_f32 v89, v39
  s_cselect_b32 s66, s48, s58
  v_exp_f32 v90, v40
  s_cselect_b32 s67, s49, s58
  v_cvt_pk_bf16_f32 v83, v88, v89
  v_exp_f32 v91, v41
  s_add_u32 s68, s52, 0
  v_exp_f32 v92, v42
  s_add_u32 m0, s51, 0
  s_mov_b64 exec, s[62:63]
  buffer_load_dwordx4 v1, s[20:23], s66 offen sc1 lds
  s_mov_b32 m0, s68
  s_mov_b64 exec, s[60:61]
  buffer_load_dwordx4 v94, s[20:23], s67 offen sc1 lds
  s_mov_b64 exec, -1
  v_mfma_f32_32x32x16_bf16 v[64:79], v[16:19], v[80:83], v[64:79]
  v_cvt_pk_bf16_f32 v84, v90, v91
  v_exp_f32 v93, v43
  s_add_u32 s48, s48, 4096
  v_exp_f32 v88, v44
  s_add_u32 s49, s49, 4096
  v_cvt_pk_bf16_f32 v85, v92, v93
  v_exp_f32 v89, v45
  s_add_u32 s50, s50, 1
  v_exp_f32 v90, v46
  v_cvt_pk_bf16_f32 v86, v88, v89
  v_exp_f32 v91, v47
  s_setprio 2
  s_waitcnt lgkmcnt(0)
  v_mfma_f32_32x32x16_bf16 v[32:47], v[8:11], v[4:7], 0
  v_cvt_pk_bf16_f32 v87, v90, v91
  v_exp_f32 v88, v48
  v_exp_f32 v89, v49
  v_exp_f32 v90, v50
  v_mfma_f32_32x32x16_bf16 v[64:79], v[20:23], v[84:87], v[64:79]
  v_exp_f32 v91, v51
  ds_read_b128 v[12:15], v99 offset:25600
  v_cvt_pk_bf16_f32 v80, v88, v89
  v_exp_f32 v92, v52
  ds_read_b128 v[16:19], v99 offset:28672
  v_cvt_pk_bf16_f32 v81, v90, v91
  v_exp_f32 v93, v53
  ds_read_b128 v[20:23], v99 offset:29696
  v_exp_f32 v88, v54
  v_cvt_pk_bf16_f32 v82, v92, v93
  v_exp_f32 v89, v55
  v_exp_f32 v90, v56
  v_cvt_pk_bf16_f32 v83, v88, v89
  v_exp_f32 v91, v57
  v_exp_f32 v92, v58
  v_mfma_f32_32x32x16_bf16 v[64:79], v[24:27], v[80:83], v[64:79]
  v_cvt_pk_bf16_f32 v84, v90, v91
  v_exp_f32 v93, v59
  v_exp_f32 v88, v60
  v_cvt_pk_bf16_f32 v85, v92, v93
  v_exp_f32 v89, v61
  v_exp_f32 v90, v62
  v_cvt_pk_bf16_f32 v86, v88, v89
  v_exp_f32 v91, v63
  s_setprio 1
  s_waitcnt lgkmcnt(0)
  v_mfma_f32_32x32x16_bf16 v[48:63], v[12:15], v[4:7], 0
  v_cvt_pk_bf16_f32 v87, v90, v91
  v_exp_f32 v88, v32
  v_exp_f32 v89, v33
  v_exp_f32 v90, v34
  v_mfma_f32_32x32x16_bf16 v[64:79], v[28:31], v[84:87], v[64:79]
  v_exp_f32 v91, v35
  ds_read_b128 v[8:11], v99 offset:26624
  v_cvt_pk_bf16_f32 v80, v88, v89
  v_exp_f32 v92, v36
  ds_read_b128 v[24:27], v99 offset:30720
  v_cvt_pk_bf16_f32 v81, v90, v91
  v_exp_f32 v93, v37
  ds_read_b128 v[28:31], v99 offset:31744
  v_exp_f32 v88, v38
  s_waitcnt vmcnt(2)
  v_cvt_pk_bf16_f32 v82, v92, v93
  v_exp_f32 v89, v39
  s_mov_b64 exec, 1
  ds_add_u32 v96, v97
  s_mov_b64 exec, -1
  v_exp_f32 v90, v40
  s_add_u32 s65, s65, 8
  v_cvt_pk_bf16_f32 v83, v88, v89
  v_exp_f32 v91, v41
  v_exp_f32 v92, v42
  v_mfma_f32_32x32x16_bf16 v[64:79], v[16:19], v[80:83], v[64:79]
  v_cvt_pk_bf16_f32 v84, v90, v91
  v_exp_f32 v93, v43
  v_exp_f32 v88, v44
  v_cvt_pk_bf16_f32 v85, v92, v93
  v_exp_f32 v89, v45
  v_exp_f32 v90, v46
  v_cvt_pk_bf16_f32 v86, v88, v89
  v_exp_f32 v91, v47
  s_setprio 0
  s_waitcnt lgkmcnt(0)
  v_mfma_f32_32x32x16_bf16 v[32:47], v[8:11], v[4:7], 0
  v_cvt_pk_bf16_f32 v87, v90, v91
  v_exp_f32 v88, v48
  v_exp_f32 v89, v49
  v_exp_f32 v90, v50
  v_mfma_f32_32x32x16_bf16 v[64:79], v[20:23], v[84:87], v[64:79]
  v_exp_f32 v91, v51
  ds_read_b128 v[12:15], v99 offset:27648
  v_cvt_pk_bf16_f32 v80, v88, v89
  v_exp_f32 v92, v52
  ds_read_b128 v[16:19], v99 offset:32768
  v_cvt_pk_bf16_f32 v81, v90, v91
  v_exp_f32 v93, v53
  ds_read_b128 v[20:23], v99 offset:33792
  v_exp_f32 v88, v54
  ds_read_b32 v98, v96
  v_cvt_pk_bf16_f32 v82, v92, v93
  v_exp_f32 v89, v55
  v_exp_f32 v90, v56
  v_cvt_pk_bf16_f32 v83, v88, v89
  v_exp_f32 v91, v57
  v_exp_f32 v92, v58
  v_mfma_f32_32x32x16_bf16 v[64:79], v[24:27], v[80:83], v[64:79]
  v_cvt_pk_bf16_f32 v84, v90, v91
  v_exp_f32 v93, v59
  v_exp_f32 v88, v60
  v_cvt_pk_bf16_f32 v85, v92, v93
  v_exp_f32 v89, v61
  v_exp_f32 v90, v62
  v_cvt_pk_bf16_f32 v86, v88, v89
  v_exp_f32 v91, v63
  s_setprio 3
  s_waitcnt lgkmcnt(0)
  v_readfirstlane_b32 s70, v98
  s_nop 0
  s_cmp_ge_u32 s70, s65
  s_cbranch_scc1 L_go_43
L_spin_42:
  s_add_u32 s71, s71, 1
  s_cmp_gt_u32 s71, 131072
  s_cbranch_scc1 L_go_43
  ds_read_b32 v98, v96
  s_waitcnt lgkmcnt(0)
  v_readfirstlane_b32 s70, v98
  s_nop 0
  s_cmp_ge_u32 s70, s65
  s_cbranch_scc0 L_spin_42
L_go_43:
  v_mfma_f32_32x32x16_bf16 v[48:63], v[12:15], v[4:7], 0
  v_cvt_pk_bf16_f32 v87, v90, v91
  v_exp_f32 v88, v32
  v_exp_f32 v89, v33
  v_exp_f32 v90, v34
  v_mfma_f32_32x32x16_bf16 v[64:79], v[28:31], v[84:87], v[64:79]
  v_exp_f32 v91, v35
  ds_read_b128 v[8:11], v99 offset:36864
  v_cvt_pk_bf16_f32 v80, v88, v89
  v_exp_f32 v92, v36
  ds_read_b128 v[24:27], v99 offset:34816
  v_cvt_pk_bf16_f32 v81, v90, v91
  v_exp_f32 v93, v37
  ds_read_b128 v[28:31], v99 offset:35840
  v_exp_f32 v88, v38
  s_cmp_lt_u32 s50, 16
  v_cvt_pk_bf16_f32 v82, v92, v93
  v_exp_f32 v89, v39
  s_cselect_b32 s66, s48, s58
  v_exp_f32 v90, v40
  s_cselect_b32 s67, s49, s58
  v_cvt_pk_bf16_f32 v83, v88, v89
  v_exp_f32 v91, v41
  s_add_u32 s68, s52, 12288
  v_exp_f32 v92, v42
  s_add_u32 m0, s51, 12288
  s_mov_b64 exec, s[62:63]
  buffer_load_dwordx4 v1, s[20:23], s66 offen sc1 lds
  s_mov_b32 m0, s68
  s_mov_b64 exec, s[60:61]
  buffer_load_dwordx4 v94, s[20:23], s67 offen sc1 lds
  s_mov_b64 exec, -1
  v_mfma_f32_32x32x16_bf16 v[64:79], v[16:19], v[80:83], v[64:79]
  v_cvt_pk_bf16_f32 v84, v90, v91
  v_exp_f32 v93, v43
  s_add_u32 s48, s48, 4096
  v_exp_f32 v88, v44
  s_add_u32 s49, s49, 4096
  v_cvt_pk_bf16_f32 v85, v92, v93
  v_exp_f32 v89, v45
  s_add_u32 s50, s50, 1
  v_exp_f32 v90, v46
  v_cvt_pk_bf16_f32 v86, v88, v89
  v_exp_f32 v91, v47
  s_setprio 2
  s_waitcnt lgkmcnt(0)
  v_mfma_f32_32x32x16_bf16 v[32:47], v[8:11], v[4:7], 0
  v_cvt_pk_bf16_f32 v87, v90, v91
  v_exp_f32 v88, v48
  v_exp_f32 v89, v49
  v_exp_f32 v90, v50
  v_mfma_f32_32x32x16_bf16 v[64:79], v[20:23], v[84:87], v[64:79]
  v_exp_f32 v91, v51
  ds_read_b128 v[12:15], v99 offset:37888
  v_cvt_pk_bf16_f32 v80, v88, v89
  v_exp_f32 v92, v52
  ds_read_b128 v[16:19], v99 offset:40960
  v_cvt_pk_bf16_f32 v81, v90, v91
  v_exp_f32 v93, v53
  ds_read_b128 v[20:23], v99 offset:41984
  v_exp_f32 v88, v54
  v_cvt_pk_bf16_f32 v82, v92, v93
  v_exp_f32 v89, v55
  v_exp_f32 v90, v56
  v_cvt_pk_bf16_f32 v83, v88, v89
  v_exp_f32 v91, v57
  v_exp_f32 v92, v58
  v_mfma_f32_32x32x16_bf16 v[64:79], v[24:27], v[80:83], v[64:79]
  v_cvt_pk_bf16_f32 v84, v90, v91
  v_exp_f32 v93, v59
  v_exp_f32 v88, v60
  v_cvt_pk_bf16_f32 v85, v92, v93
  v_exp_f32 v89, v61
  v_exp_f32 v90, v62
  v_cvt_pk_bf16_f32 v86, v88, v89
  v_exp_f32 v91, v63
  s_setprio 1
  s_waitcnt lgkmcnt(0)
  v_mfma_f32_32x32x16_bf16 v[48:63], v[12:15], v[4:7], 0
  v_cvt_pk_bf16_f32 v87, v90, v91
  v_exp_f32 v88, v32
  v_exp_f32 v89, v33
  v_exp_f32 v90, v34
  v_mfma_f32_32x32x16_bf16 v[64:79], v[28:31], v[84:87], v[64:79]
  v_exp_f32 v91, v35
  ds_read_b128 v[8:11], v99 offset:38912
  v_cvt_pk_bf16_f32 v80, v88, v89
  v_exp_f32 v92, v36
  ds_read_b128 v[24:27], v99 offset:43008
  v_cvt_pk_bf16_f32 v81, v90, v91
  v_exp_f32 v93, v37
  ds_read_b128 v[28:31], v99 offset:44032
  v_exp_f32 v88, v38
  s_waitcnt vmcnt(2)
  v_cvt_pk_bf16_f32 v82, v92, v93
  v_exp_f32 v89, v39
  s_mov_b64 exec, 1
  ds_add_u32 v96, v97
  s_mov_b64 exec, -1
  v_exp_f32 v90, v40
  s_add_u32 s65, s65, 8
  v_cvt_pk_bf16_f32 v83, v88, v89
  v_exp_f32 v91, v41
  v_exp_f32 v92, v42
  v_mfma_f32_32x32x16_bf16 v[64:79], v[16:19], v[80:83], v[64:79]
  v_cvt_pk_bf16_f32 v84, v90, v91
  v_exp_f32 v93, v43
  v_exp_f32 v88, v44
  v_cvt_pk_bf16_f32 v85, v92, v93
  v_exp_f32 v89, v45
  v_exp_f32 v90, v46
  v_cvt_pk_bf16_f32 v86, v88, v89
  v_exp_f32 v91, v47
  s_setprio 0
  s_waitcnt lgkmcnt(0)
  v_mfma_f32_32x32x16_bf16 v[32:47], v[8:11], v[4:7], 0
  v_cvt_pk_bf16_f32 v87, v90, v91
  v_exp_f32 v88, v48
  v_exp_f32 v89, v49
  v_exp_f32 v90, v50
  v_mfma_f32_32x32x16_bf16 v[64:79], v[20:23], v[84:87], v[64:79]
  v_exp_f32 v91, v51
  ds_read_b128 v[12:15], v99 offset:39936
  v_cvt_pk_bf16_f32 v80, v88, v89
  v_exp_f32 v92, v52
  ds_read_b128 v[16:19], v99 offset:45056
  v_cvt_pk_bf16_f32 v81, v90, v91
  v_exp_f32 v93, v53
  ds_read_b128 v[20:23], v99 offset:46080
  v_exp_f32 v88, v54
  ds_read_b32 v98, v96
  v_cvt_pk_bf16_f32 v82, v92, v93
  v_exp_f32 v89, v55
  v_exp_f32 v90, v56
  v_cvt_pk_bf16_f32 v83, v88, v89
  v_exp_f32 v91, v57
  v_exp_f32 v92, v58
  v_mfma_f32_32x32x16_bf16 v[64:79], v[24:27], v[80:83], v[64:79]
  v_cvt_pk_bf16_f32 v84, v90, v91
  v_exp_f32 v93, v59
  v_exp_f32 v88, v60
  v_cvt_pk_bf16_f32 v85, v92, v93
  v_exp_f32 v89, v61
  v_exp_f32 v90, v62
  v_cvt_pk_bf16_f32 v86, v88, v89
  v_exp_f32 v91, v63
  s_setprio 3
  s_waitcnt lgkmcnt(0)
  v_readfirstlane_b32 s70, v98
  s_nop 0
  s_cmp_ge_u32 s70, s65
  s_cbranch_scc1 L_go_45
L_spin_44:
  s_add_u32 s71, s71, 1
  s_cmp_gt_u32 s71, 131072
  s_cbranch_scc1 L_go_45
  ds_read_b32 v98, v96
  s_waitcnt lgkmcnt(0)
  v_readfirstlane_b32 s70, v98
  s_nop 0
  s_cmp_ge_u32 s70, s65
  s_cbranch_scc0 L_spin_44
L_go_45:
  v_mfma_f32_32x32x16_bf16 v[48:63], v[12:15], v[4:7], 0
  v_cvt_pk_bf16_f32 v87, v90, v91
  v_exp_f32 v88, v32
  v_exp_f32 v89, v33
  v_exp_f32 v90, v34
  v_mfma_f32_32x32x16_bf16 v[64:79], v[28:31], v[84:87], v[64:79]
  v_exp_f32 v91, v35
  ds_read_b128 v[8:11], v99 offset:0
  v_cvt_pk_bf16_f32 v80, v88, v89
  v_exp_f32 v92, v36
  ds_read_b128 v[24:27], v99 offset:47104
  v_cvt_pk_bf16_f32 v81, v90, v91
  v_exp_f32 v93, v37
  ds_read_b128 v[28:31], v99 offset:48128
  v_exp_f32 v88, v38
  s_cmp_lt_u32 s50, 16
  v_cvt_pk_bf16_f32 v82, v92, v93
  v_exp_f32 v89, v39
  s_cselect_b32 s66, s48, s58
  v_exp_f32 v90, v40
  s_cselect_b32 s67, s49, s58
  v_cvt_pk_bf16_f32 v83, v88, v89
  v_exp_f32 v91, v41
  s_add_u32 s68, s52, 24576
  v_exp_f32 v92, v42
  s_add_u32 m0, s51, 24576
  s_mov_b64 exec, s[62:63]
  buffer_load_dwordx4 v1, s[20:23], s66 offen sc1 lds
  s_mov_b32 m0, s68
  s_mov_b64 exec, s[60:61]
  buffer_load_dwordx4 v94, s[20:23], s67 offen sc1 lds
  s_mov_b64 exec, -1
  v_mfma_f32_32x32x16_bf16 v[64:79], v[16:19], v[80:83], v[64:79]
  v_cvt_pk_bf16_f32 v84, v90, v91
  v_exp_f32 v93, v43
  s_add_u32 s48, s48, 4096
  v_exp_f32 v88, v44
  s_add_u32 s49, s49, 4096
  v_cvt_pk_bf16_f32 v85, v92, v93
  v_exp_f32 v89, v45
  s_add_u32 s50, s50, 1
  v_exp_f32 v90, v46
  v_cvt_pk_bf16_f32 v86, v88, v89
  v_exp_f32 v91, v47
  s_setprio 2
  s_waitcnt lgkmcnt(0)
  v_mfma_f32_32x32x16_bf16 v[32:47], v[8:11], v[4:7], 0
  v_cvt_pk_bf16_f32 v87, v90, v91
  v_exp_f32 v88, v48
  v_exp_f32 v89, v49
  v_exp_f32 v90, v50
  v_mfma_f32_32x32x16_bf16 v[64:79], v[20:23], v[84:87], v[64:79]
  v_exp_f32 v91, v51
  ds_read_b128 v[12:15], v99 offset:1024
  v_cvt_pk_bf16_f32 v80, v88, v89
  v_exp_f32 v92, v52
  ds_read_b128 v[16:19], v99 offset:4096
  v_cvt_pk_bf16_f32 v81, v90, v91
  v_exp_f32 v93, v53
  ds_read_b128 v[20:23], v99 offset:5120
  v_exp_f32 v88, v54
  v_cvt_pk_bf16_f32 v82, v92, v93
  v_exp_f32 v89, v55
  v_exp_f32 v90, v56
  v_cvt_pk_bf16_f32 v83, v88, v89
  v_exp_f32 v91, v57
  v_exp_f32 v92, v58
  v_mfma_f32_32x32x16_bf16 v[64:79], v[24:27], v[80:83], v[64:79]
  v_cvt_pk_bf16_f32 v84, v90, v91
  v_exp_f32 v93, v59
  v_exp_f32 v88, v60
  v_cvt_pk_bf16_f32 v85, v92, v93
  v_exp_f32 v89, v61
  v_exp_f32 v90, v62
  v_cvt_pk_bf16_f32 v86, v88, v89
  v_exp_f32 v91, v63
  s_sub_u32 s64, s64, 1
  s_cmp_lg_u32 s64, 0
  s_cbranch_scc1 L_att_loop
  s_setprio 0
  s_mov_b64 exec, 1
  v_mov_b32 v104, 160004
  v_mov_b32 v105, 1
  ds_add_u32 v104, v105
  s_mov_b64 exec, -1
  v_cvt_pk_bf16_f32 v87, v90, v91
  s_nop 1
  v_mfma_f32_32x32x16_bf16 v[64:79], v[28:31], v[84:87], v[64:79]
  s_waitcnt vmcnt(0) lgkmcnt(0)
  s_nop 7
  s_nop 3
  v_mul_f32 v95, 0, v64
  v_fma_f32 v95, v65, 0, v95
  v_fma_f32 v95, v66, 0, v95
  v_fma_f32 v95, v67, 0, v95
  v_fma_f32 v95, v68, 0, v95
  v_fma_f32 v95, v69, 0, v95
  v_fma_f32 v95, v70, 0, v95
  v_fma_f32 v95, v71, 0, v95
  v_cmp_eq_f32 s[66:67], 0, v95
  v_mov_b32 v88, 0x21800000
  v_cmp_le_f32 s[68:69], v88, v72
  s_nop 1
  s_and_b64 s[66:67], s[66:67], s[68:69]
  v_mov_b32 v88, 0x5d800000
  v_cmp_ge_f32 s[68:69], v88, v72
  s_nop 1
  s_and_b64 s[66:67], s[66:67], s[68:69]
  s_cmp_eq_u64 s[66:67], -1
  s_cbranch_scc0 L_att_fallback
L_att_fin:
  v_rcp_f32 v95, v72
  s_nop 0
  v_mul_f32 v64, v64, v95
  v_mul_f32 v65, v65, v95
  v_mul_f32 v66, v66, v95
  v_mul_f32 v67, v67, v95
  v_mul_f32 v68, v68, v95
  v_mul_f32 v69, v69, v95
  v_mul_f32 v70, v70, v95
  v_mul_f32 v71, v71, v95
  v_cvt_pk_bf16_f32 v80, v64, v65
  v_cvt_pk_bf16_f32 v81, v66, v67
  v_cvt_pk_bf16_f32 v82, v68, v69
  v_cvt_pk_bf16_f32 v83, v70, v71
  buffer_store_dwordx4 v[80:83], v1, s[20:23], s55 offen sc1
  s_waitcnt vmcnt(0)
  s_mov_b64 exec, 1
  v_mov_b32 v6, 0
  v_mov_b32 v7, s42
  buffer_store_dword v7, v6, s[20:23], s57 offen sc1
  s_mov_b64 exec, -1
  s_cmp_lt_u32 s40, 4
  s_cbranch_scc1 L_cend_46
  s_endpgm
L_cend_46:
  s_and_b32 s48, s2, 7
  s_lshr_b32 s49, s2, 3
  s_lshl_b32 s50, s48, 2
  s_and_b32 s51, s49, 3
  s_add_u32 s50, s50, s51
  s_lshr_b32 s51, s49, 2
  s_mul_i32 s52, s50, 8704
  s_add_u32 s52, s52, 17825792
  v_lshrrev_b32 v7, 5, v3
  v_lshlrev_b32 v7, 10, v7
  v_bfe_u32 v8, v3, 4, 1
  v_lshlrev_b32 v8, 9, v8
  v_and_b32 v9, 15, v3
  v_lshlrev_b32 v9, 4, v9
  v_add3_u32 v6, v7, v8, v9
  v_and_b32 v7, 1, v2
  v_lshl_add_u32 v6, v7, 8, v6
  s_lshl_b32 s53, s50, 1
  s_lshr_b32 s54, s41, 1
  s_add_u32 s53, s53, s54
  s_lshl_b32 s53, s53, 15
  s_add_u32 s53, s53, 6291456
  v_lshrrev_b32 v7, 5, v3
  v_lshlrev_b32 v7, 4, v7
  v_bfe_u32 v8, v3, 4, 1
  v_lshl_add_u32 v7, v8, 2, v7
  v_bfe_u32 v9, v3, 2, 2
  v_add_u32 v7, v7, v9
  v_lshlrev_b32 v7, 7, v7
  v_and_b32 v9, 2, v9
  v_lshl_add_u32 v9, v8, 2, v9
  v_bfe_u32 v8, v3, 1, 1
  v_lshl_add_u32 v7, v8, 4, v7
  v_and_b32 v8, 1, v3
  v_lshl_add_u32 v7, v8, 3, v7
  v_xor_b32 v8, 0, v9
  v_lshl_add_u32 v11, v8, 4, v7
  v_xor_b32 v8, 2, v9
  v_lshl_add_u32 v12, v8, 4, v7
  v_xor_b32 v8, 4, v9
  v_lshl_add_u32 v13, v8, 4, v7
  v_xor_b32 v8, 6, v9
  v_lshl_add_u32 v14, v8, 4, v7
  v_mov_b32 v8, 159996
L_lw_47:
  ds_read_b32 v9, v8
  s_waitcnt lgkmcnt(0)
  v_readfirstlane_b32 s70, v9
  s_nop 0
  s_cmp_ge_u32 s70, 4
  s_cbranch_scc1 L_lwok_48
  s_add_u32 s71, s71, 1
  s_cmp_gt_u32 s71, 131072
  s_cbranch_scc1 L_lwok_48
  s_sleep 1
  s_branch L_lw_47
L_lwok_48:
  ds_read_b64_tr_b16 v[96:97], v11 offset:0
  ds_read_b64_tr_b16 v[98:99], v11 offset:1024
  ds_read_b64_tr_b16 v[100:101], v12 offset:0
  ds_read_b64_tr_b16 v[102:103], v12 offset:1024
  ds_read_b64_tr_b16 v[104:105], v13 offset:0
  ds_read_b64_tr_b16 v[106:107], v13 offset:1024
  ds_read_b64_tr_b16 v[108:109], v14 offset:0
  ds_read_b64_tr_b16 v[110:111], v14 offset:1024
  s_lshr_b32 s55, s41, 1
  s_mul_i32 s56, s55, 4352
  s_add_u32 s52, s52, s56
  s_lshl_b32 s56, s55, 2
  s_add_u32 s56, s56, 159972
  s_bitcmp1_b32 s41, 0
  s_cbranch_scc1 L_fo_49
  s_mov_b32 exec_lo, 0xffffffff
  s_mov_b32 exec_hi, 0
  v_lshlrev_b32 v8, 2, v3
L_pf_51:
  buffer_load_dword v9, v8, s[20:23], s52 offen sc1
  s_waitcnt vmcnt(0)
  v_cmp_ne_u32 vcc, s42, v9
  s_nop 1
  s_cbranch_vccz L_pfok_52
  s_add_u32 s71, s71, 1
  s_cmp_gt_u32 s71, 131072
  s_cbranch_scc1 L_pfok_52
  s_sleep 2
  s_branch L_pf_51
L_pfok_52:
  s_mov_b64 exec, -1
  s_mov_b64 exec, 1
  v_mov_b32 v8, s56
  v_mov_b32 v9, 1
  ds_write_b32 v8, v9
  s_mov_b64 exec, -1
  s_branch L_fod_50
L_fo_49:
  v_mov_b32 v8, s56
L_fw_53:
  ds_read_b32 v9, v8
  s_waitcnt lgkmcnt(0)
  v_readfirstlane_b32 s70, v9
  s_nop 0
  s_cmp_ge_u32 s70, 1
  s_cbranch_scc1 L_fwok_54
  s_add_u32 s71, s71, 1
  s_cmp_gt_u32 s71, 131072
  s_cbranch_scc1 L_fwok_54
  s_sleep 1
  s_branch L_fw_53
L_fwok_54:
L_fod_50:
  s_add_u32 s54, s53, 0
  buffer_load_dwordx4 v[16:19], v6, s[20:23], s54 offen offset:0 sc1
  buffer_load_dwordx4 v[20:23], v6, s[20:23], s54 offen offset:2048 sc1
  s_add_u32 s54, s53, 4096
  buffer_load_dwordx4 v[24:27], v6, s[20:23], s54 offen offset:0 sc1
  buffer_load_dwordx4 v[28:31], v6, s[20:23], s54 offen offset:2048 sc1
  s_add_u32 s54, s53, 8192
  buffer_load_dwordx4 v[32:35], v6, s[20:23], s54 offen offset:0 sc1
  buffer_load_dwordx4 v[36:39], v6, s[20:23], s54 offen offset:2048 sc1
  s_add_u32 s54, s53, 12288
  buffer_load_dwordx4 v[40:43], v6, s[20:23], s54 offen offset:0 sc1
  buffer_load_dwordx4 v[44:47], v6, s[20:23], s54 offen offset:2048 sc1
  s_add_u32 s54, s53, 16384
  buffer_load_dwordx4 v[48:51], v6, s[20:23], s54 offen offset:0 sc1
  buffer_load_dwordx4 v[52:55], v6, s[20:23], s54 offen offset:2048 sc1
  s_add_u32 s54, s53, 20480
  buffer_load_dwordx4 v[56:59], v6, s[20:23], s54 offen offset:0 sc1
  buffer_load_dwordx4 v[60:63], v6, s[20:23], s54 offen offset:2048 sc1
  s_add_u32 s54, s53, 24576
  buffer_load_dwordx4 v[64:67], v6, s[20:23], s54 offen offset:0 sc1
  buffer_load_dwordx4 v[68:71], v6, s[20:23], s54 offen offset:2048 sc1
  s_add_u32 s54, s53, 28672
  buffer_load_dwordx4 v[72:75], v6, s[20:23], s54 offen offset:0 sc1
  buffer_load_dwordx4 v[76:79], v6, s[20:23], s54 offen offset:2048 sc1
  v_and_b32 v7, 15, v3
  v_lshlrev_b32 v7, 11, v7
  v_lshrrev_b32 v8, 4, v3
  v_lshl_add_u32 v7, v8, 3, v7
  s_lshl_b32 s53, s50, 6
  s_lshl_b32 s54, s41, 4
  s_add_u32 s53, s53, s54
  s_lshl_b32 s53, s53, 11
  s_lshl_b32 s54, s51, 7
  s_add_u32 s53, s53, s54
  ds_read_b64_tr_b16 v[112:113], v11 offset:4096
  ds_read_b64_tr_b16 v[114:115], v11 offset:5120
  ds_read_b64_tr_b16 v[116:117], v12 offset:4096
  ds_read_b64_tr_b16 v[118:119], v12 offset:5120
  ds_read_b64_tr_b16 v[120:121], v13 offset:4096
  ds_read_b64_tr_b16 v[122:123], v13 offset:5120
  ds_read_b64_tr_b16 v[124:125], v14 offset:4096
  ds_read_b64_tr_b16 v[126:127], v14 offset:5120
  s_waitcnt lgkmcnt(8)
  s_waitcnt vmcnt(15)
  v_mfma_f32_16x16x32_bf16 v[80:83], v[96:99], v[16:19], 0
  v_mfma_f32_16x16x32_bf16 v[84:87], v[100:103], v[16:19], 0
  v_mfma_f32_16x16x32_bf16 v[88:91], v[104:107], v[16:19], 0
  v_mfma_f32_16x16x32_bf16 v[92:95], v[108:111], v[16:19], 0
  ds_read_b64_tr_b16 v[96:97], v11 offset:8192
  ds_read_b64_tr_b16 v[98:99], v11 offset:9216
  ds_read_b64_tr_b16 v[100:101], v12 offset:8192
  ds_read_b64_tr_b16 v[102:103], v12 offset:9216
  ds_read_b64_tr_b16 v[104:105], v13 offset:8192
  ds_read_b64_tr_b16 v[106:107], v13 offset:9216
  ds_read_b64_tr_b16 v[108:109], v14 offset:8192
  ds_read_b64_tr_b16 v[110:111], v14 offset:9216
  s_waitcnt lgkmcnt(8)
  s_waitcnt vmcnt(14)
  v_mfma_f32_16x16x32_bf16 v[80:83], v[112:115], v[20:23], v[80:83]
  v_mfma_f32_16x16x32_bf16 v[84:87], v[116:119], v[20:23], v[84:87]
  v_mfma_f32_16x16x32_bf16 v[88:91], v[120:123], v[20:23], v[88:91]
  v_mfma_f32_16x16x32_bf16 v[92:95], v[124:127], v[20:23], v[92:95]
  ds_read_b64_tr_b16 v[112:113], v11 offset:12288
  ds_read_b64_tr_b16 v[114:115], v11 offset:13312
  ds_read_b64_tr_b16 v[116:117], v12 offset:12288
  ds_read_b64_tr_b16 v[118:119], v12 offset:13312
  ds_read_b64_tr_b16 v[120:121], v13 offset:12288
  ds_read_b64_tr_b16 v[122:123], v13 offset:13312
  ds_read_b64_tr_b16 v[124:125], v14 offset:12288
  ds_read_b64_tr_b16 v[126:127], v14 offset:13312
  s_waitcnt lgkmcnt(8)
  s_waitcnt vmcnt(13)
  v_mfma_f32_16x16x32_bf16 v[80:83], v[96:99], v[24:27], v[80:83]
  v_mfma_f32_16x16x32_bf16 v[84:87], v[100:103], v[24:27], v[84:87]
  v_mfma_f32_16x16x32_bf16 v[88:91], v[104:107], v[24:27], v[88:91]
  v_mfma_f32_16x16x32_bf16 v[92:95], v[108:111], v[24:27], v[92:95]
  ds_read_b64_tr_b16 v[96:97], v11 offset:16384
  ds_read_b64_tr_b16 v[98:99], v11 offset:17408
  ds_read_b64_tr_b16 v[100:101], v12 offset:16384
  ds_read_b64_tr_b16 v[102:103], v12 offset:17408
  ds_read_b64_tr_b16 v[104:105], v13 offset:16384
  ds_read_b64_tr_b16 v[106:107], v13 offset:17408
  ds_read_b64_tr_b16 v[108:109], v14 offset:16384
  ds_read_b64_tr_b16 v[110:111], v14 offset:17408
  s_waitcnt lgkmcnt(8)
  s_waitcnt vmcnt(12)
  v_mfma_f32_16x16x32_bf16 v[80:83], v[112:115], v[28:31], v[80:83]
  v_mfma_f32_16x16x32_bf16 v[84:87], v[116:119], v[28:31], v[84:87]
  v_mfma_f32_16x16x32_bf16 v[88:91], v[120:123], v[28:31], v[88:91]
  v_mfma_f32_16x16x32_bf16 v[92:95], v[124:127], v[28:31], v[92:95]
  ds_read_b64_tr_b16 v[112:113], v11 offset:20480
  ds_read_b64_tr_b16 v[114:115], v11 offset:21504
  ds_read_b64_tr_b16 v[116:117], v12 offset:20480
  ds_read_b64_tr_b16 v[118:119], v12 offset:21504
  ds_read_b64_tr_b16 v[120:121], v13 offset:20480
  ds_read_b64_tr_b16 v[122:123], v13 offset:21504
  ds_read_b64_tr_b16 v[124:125], v14 offset:20480
  ds_read_b64_tr_b16 v[126:127], v14 offset:21504
  s_waitcnt lgkmcnt(8)
  s_waitcnt vmcnt(11)
  v_mfma_f32_16x16x32_bf16 v[80:83], v[96:99], v[32:35], v[80:83]
  v_mfma_f32_16x16x32_bf16 v[84:87], v[100:103], v[32:35], v[84:87]
  v_mfma_f32_16x16x32_bf16 v[88:91], v[104:107], v[32:35], v[88:91]
  v_mfma_f32_16x16x32_bf16 v[92:95], v[108:111], v[32:35], v[92:95]
  ds_read_b64_tr_b16 v[96:97], v11 offset:24576
  ds_read_b64_tr_b16 v[98:99], v11 offset:25600
  ds_read_b64_tr_b16 v[100:101], v12 offset:24576
  ds_read_b64_tr_b16 v[102:103], v12 offset:25600
  ds_read_b64_tr_b16 v[104:105], v13 offset:24576
  ds_read_b64_tr_b16 v[106:107], v13 offset:25600
  ds_read_b64_tr_b16 v[108:109], v14 offset:24576
  ds_read_b64_tr_b16 v[110:111], v14 offset:25600
  s_waitcnt lgkmcnt(8)
  s_waitcnt vmcnt(10)
  v_mfma_f32_16x16x32_bf16 v[80:83], v[112:115], v[36:39], v[80:83]
  v_mfma_f32_16x16x32_bf16 v[84:87], v[116:119], v[36:39], v[84:87]
  v_mfma_f32_16x16x32_bf16 v[88:91], v[120:123], v[36:39], v[88:91]
  v_mfma_f32_16x16x32_bf16 v[92:95], v[124:127], v[36:39], v[92:95]
  ds_read_b64_tr_b16 v[112:113], v11 offset:28672
  ds_read_b64_tr_b16 v[114:115], v11 offset:29696
  ds_read_b64_tr_b16 v[116:117], v12 offset:28672
  ds_read_b64_tr_b16 v[118:119], v12 offset:29696
  ds_read_b64_tr_b16 v[120:121], v13 offset:28672
  ds_read_b64_tr_b16 v[122:123], v13 offset:29696
  ds_read_b64_tr_b16 v[124:125], v14 offset:28672
  ds_read_b64_tr_b16 v[126:127], v14 offset:29696
  s_waitcnt lgkmcnt(8)
  s_waitcnt vmcnt(9)
  v_mfma_f32_16x16x32_bf16 v[80:83], v[96:99], v[40:43], v[80:83]
  v_mfma_f32_16x16x32_bf16 v[84:87], v[100:103], v[40:43], v[84:87]
  v_mfma_f32_16x16x32_bf16 v[88:91], v[104:107], v[40:43], v[88:91]
  v_mfma_f32_16x16x32_bf16 v[92:95], v[108:111], v[40:43], v[92:95]
  ds_read_b64_tr_b16 v[96:97], v11 offset:32768
  ds_read_b64_tr_b16 v[98:99], v11 offset:33792
  ds_read_b64_tr_b16 v[100:101], v12 offset:32768
  ds_read_b64_tr_b16 v[102:103], v12 offset:33792
  ds_read_b64_tr_b16 v[104:105], v13 offset:32768
  ds_read_b64_tr_b16 v[106:107], v13 offset:33792
  ds_read_b64_tr_b16 v[108:109], v14 offset:32768
  ds_read_b64_tr_b16 v[110:111], v14 offset:33792
  s_waitcnt lgkmcnt(8)
  s_waitcnt vmcnt(8)
  v_mfma_f32_16x16x32_bf16 v[80:83], v[112:115], v[44:47], v[80:83]
  v_mfma_f32_16x16x32_bf16 v[84:87], v[116:119], v[44:47], v[84:87]
  v_mfma_f32_16x16x32_bf16 v[88:91], v[120:123], v[44:47], v[88:91]
  v_mfma_f32_16x16x32_bf16 v[92:95], v[124:127], v[44:47], v[92:95]
  ds_read_b64_tr_b16 v[112:113], v11 offset:36864
  ds_read_b64_tr_b16 v[114:115], v11 offset:37888
  ds_read_b64_tr_b16 v[116:117], v12 offset:36864
  ds_read_b64_tr_b16 v[118:119], v12 offset:37888
  ds_read_b64_tr_b16 v[120:121], v13 offset:36864
  ds_read_b64_tr_b16 v[122:123], v13 offset:37888
  ds_read_b64_tr_b16 v[124:125], v14 offset:36864
  ds_read_b64_tr_b16 v[126:127], v14 offset:37888
  s_waitcnt lgkmcnt(8)
  s_waitcnt vmcnt(7)
  v_mfma_f32_16x16x32_bf16 v[80:83], v[96:99], v[48:51], v[80:83]
  v_mfma_f32_16x16x32_bf16 v[84:87], v[100:103], v[48:51], v[84:87]
  v_mfma_f32_16x16x32_bf16 v[88:91], v[104:107], v[48:51], v[88:91]
  v_mfma_f32_16x16x32_bf16 v[92:95], v[108:111], v[48:51], v[92:95]
  ds_read_b64_tr_b16 v[96:97], v11 offset:40960
  ds_read_b64_tr_b16 v[98:99], v11 offset:41984
  ds_read_b64_tr_b16 v[100:101], v12 offset:40960
  ds_read_b64_tr_b16 v[102:103], v12 offset:41984
  ds_read_b64_tr_b16 v[104:105], v13 offset:40960
  ds_read_b64_tr_b16 v[106:107], v13 offset:41984
  ds_read_b64_tr_b16 v[108:109], v14 offset:40960
  ds_read_b64_tr_b16 v[110:111], v14 offset:41984
  s_waitcnt lgkmcnt(8)
  s_waitcnt vmcnt(6)
  v_mfma_f32_16x16x32_bf16 v[80:83], v[112:115], v[52:55], v[80:83]
  v_mfma_f32_16x16x32_bf16 v[84:87], v[116:119], v[52:55], v[84:87]
  v_mfma_f32_16x16x32_bf16 v[88:91], v[120:123], v[52:55], v[88:91]
  v_mfma_f32_16x16x32_bf16 v[92:95], v[124:127], v[52:55], v[92:95]
  ds_read_b64_tr_b16 v[112:113], v11 offset:45056
  ds_read_b64_tr_b16 v[114:115], v11 offset:46080
  ds_read_b64_tr_b16 v[116:117], v12 offset:45056
  ds_read_b64_tr_b16 v[118:119], v12 offset:46080
  ds_read_b64_tr_b16 v[120:121], v13 offset:45056
  ds_read_b64_tr_b16 v[122:123], v13 offset:46080
  ds_read_b64_tr_b16 v[124:125], v14 offset:45056
  ds_read_b64_tr_b16 v[126:127], v14 offset:46080
  s_waitcnt lgkmcnt(8)
  s_waitcnt vmcnt(5)
  v_mfma_f32_16x16x32_bf16 v[80:83], v[96:99], v[56:59], v[80:83]
  v_mfma_f32_16x16x32_bf16 v[84:87], v[100:103], v[56:59], v[84:87]
  v_mfma_f32_16x16x32_bf16 v[88:91], v[104:107], v[56:59], v[88:91]
  v_mfma_f32_16x16x32_bf16 v[92:95], v[108:111], v[56:59], v[92:95]
  ds_read_b64_tr_b16 v[96:97], v11 offset:49152
  ds_read_b64_tr_b16 v[98:99], v11 offset:50176
  ds_read_b64_tr_b16 v[100:101], v12 offset:49152
  ds_read_b64_tr_b16 v[102:103], v12 offset:50176
  ds_read_b64_tr_b16 v[104:105], v13 offset:49152
  ds_read_b64_tr_b16 v[106:107], v13 offset:50176
  ds_read_b64_tr_b16 v[108:109], v14 offset:49152
  ds_read_b64_tr_b16 v[110:111], v14 offset:50176
  s_waitcnt lgkmcnt(8)
  s_waitcnt vmcnt(4)
  v_mfma_f32_16x16x32_bf16 v[80:83], v[112:115], v[60:63], v[80:83]
  v_mfma_f32_16x16x32_bf16 v[84:87], v[116:119], v[60:63], v[84:87]
  v_mfma_f32_16x16x32_bf16 v[88:91], v[120:123], v[60:63], v[88:91]
  v_mfma_f32_16x16x32_bf16 v[92:95], v[124:127], v[60:63], v[92:95]
  ds_read_b64_tr_b16 v[112:113], v11 offset:53248
  ds_read_b64_tr_b16 v[114:115], v11 offset:54272
  ds_read_b64_tr_b16 v[116:117], v12 offset:53248
  ds_read_b64_tr_b16 v[118:119], v12 offset:54272
  ds_read_b64_tr_b16 v[120:121], v13 offset:53248
  ds_read_b64_tr_b16 v[122:123], v13 offset:54272
  ds_read_b64_tr_b16 v[124:125], v14 offset:53248
  ds_read_b64_tr_b16 v[126:127], v14 offset:54272
  s_waitcnt lgkmcnt(8)
  s_waitcnt vmcnt(3)
  v_mfma_f32_16x16x32_bf16 v[80:83], v[96:99], v[64:67], v[80:83]
  v_mfma_f32_16x16x32_bf16 v[84:87], v[100:103], v[64:67], v[84:87]
  v_mfma_f32_16x16x32_bf16 v[88:91], v[104:107], v[64:67], v[88:91]
  v_mfma_f32_16x16x32_bf16 v[92:95], v[108:111], v[64:67], v[92:95]
  ds_read_b64_tr_b16 v[96:97], v11 offset:57344
  ds_read_b64_tr_b16 v[98:99], v11 offset:58368
  ds_read_b64_tr_b16 v[100:101], v12 offset:57344
  ds_read_b64_tr_b16 v[102:103], v12 offset:58368
  ds_read_b64_tr_b16 v[104:105], v13 offset:57344
  ds_read_b64_tr_b16 v[106:107], v13 offset:58368
  ds_read_b64_tr_b16 v[108:109], v14 offset:57344
  ds_read_b64_tr_b16 v[110:111], v14 offset:58368
  s_waitcnt lgkmcnt(8)
  s_waitcnt vmcnt(2)
  v_mfma_f32_16x16x32_bf16 v[80:83], v[112:115], v[68:71], v[80:83]
  v_mfma_f32_16x16x32_bf16 v[84:87], v[116:119], v[68:71], v[84:87]
  v_mfma_f32_16x16x32_bf16 v[88:91], v[120:123], v[68:71], v[88:91]
  v_mfma_f32_16x16x32_bf16 v[92:95], v[124:127], v[68:71], v[92:95]
  ds_read_b64_tr_b16 v[112:113], v11 offset:61440
  ds_read_b64_tr_b16 v[114:115], v11 offset:62464
  ds_read_b64_tr_b16 v[116:117], v12 offset:61440
  ds_read_b64_tr_b16 v[118:119], v12 offset:62464
  ds_read_b64_tr_b16 v[120:121], v13 offset:61440
  ds_read_b64_tr_b16 v[122:123], v13 offset:62464
  ds_read_b64_tr_b16 v[124:125], v14 offset:61440
  ds_read_b64_tr_b16 v[126:127], v14 offset:62464
  s_waitcnt lgkmcnt(8)
  s_waitcnt vmcnt(1)
  v_mfma_f32_16x16x32_bf16 v[80:83], v[96:99], v[72:75], v[80:83]
  v_mfma_f32_16x16x32_bf16 v[84:87], v[100:103], v[72:75], v[84:87]
  v_mfma_f32_16x16x32_bf16 v[88:91], v[104:107], v[72:75], v[88:91]
  v_mfma_f32_16x16x32_bf16 v[92:95], v[108:111], v[72:75], v[92:95]
  s_waitcnt lgkmcnt(0)
  s_waitcnt vmcnt(0)
  v_mfma_f32_16x16x32_bf16 v[80:83], v[112:115], v[76:79], v[80:83]
  v_mfma_f32_16x16x32_bf16 v[84:87], v[116:119], v[76:79], v[84:87]
  v_mfma_f32_16x16x32_bf16 v[88:91], v[120:123], v[76:79], v[88:91]
  v_mfma_f32_16x16x32_bf16 v[92:95], v[124:127], v[76:79], v[92:95]
  s_nop 4
  v_cvt_pk_bf16_f32 v96, v80, v81
  v_cvt_pk_bf16_f32 v97, v82, v83
  buffer_store_dwordx2 v[96:97], v7, s[32:35], s53 offen offset:0
  v_cvt_pk_bf16_f32 v98, v84, v85
  v_cvt_pk_bf16_f32 v99, v86, v87
  buffer_store_dwordx2 v[98:99], v7, s[32:35], s53 offen offset:32
  v_cvt_pk_bf16_f32 v100, v88, v89
  v_cvt_pk_bf16_f32 v101, v90, v91
  buffer_store_dwordx2 v[100:101], v7, s[32:35], s53 offen offset:64
  v_cvt_pk_bf16_f32 v102, v92, v93
  v_cvt_pk_bf16_f32 v103, v94, v95
  buffer_store_dwordx2 v[102:103], v7, s[32:35], s53 offen offset:96
  s_endpgm
L_B_p1:
  s_setprio 3
  v_lshrrev_b32 v4, 3, v3
  v_lshlrev_b32 v4, 10, v4
  v_and_b32 v5, 7, v3
  v_lshrrev_b32 v6, 4, v3
  v_xor_b32 v5, v5, v6
  v_lshlrev_b32 v5, 4, v5
  v_add_u32 v16, v4, v5
  v_xor_b32 v17, 64, v16
  v_add_u32 v17, 8192, v17
  v_lshrrev_b32 v4, 4, v3
  v_bfe_u32 v5, v3, 2, 2
  v_xor_b32 v5, v5, v4
  v_lshrrev_b32 v6, 1, v5
  v_add_u32 v6, 1, v6
  v_lshlrev_b32 v6, 10, v6
  v_and_b32 v5, 1, v5
  v_lshl_add_u32 v6, v5, 6, v6
  v_and_b32 v5, 3, v3
  v_lshl_add_u32 v6, v5, 4, v6
  v_lshl_add_u32 v4, v2, 4, v4
  v_mul_u32_u24 v4, 3072, v4
  v_add_u32 v18, v4, v6
  v_lshrrev_b32 v4, 3, v3
  v_bfe_u32 v5, v3, 4, 1
  v_lshlrev_b32 v5, 2, v5
  v_and_b32 v6, 7, v3
  v_xor_b32 v5, v5, v6
  v_lshlrev_b32 v5, 4, v5
  v_lshl_add_u32 v4, v2, 4, v4
  v_mul_u32_u24 v4, 3072, v4
  v_add_u32 v19, v4, v5
  s_waitcnt lgkmcnt(0)
  s_mov_b32 s4, s48
  s_mov_b32 s5, s49
  s_mov_b32 s6, 2097152
  s_mov_b32 s7, 0x20000
  s_mov_b32 s8, s50
  s_mov_b32 s9, s51
  s_mov_b32 s10, 1572864
  s_mov_b32 s11, 0x20000
  s_mov_b32 s12, s54
  s_mov_b32 s13, s55
  s_mov_b32 s14, 2097152
  s_mov_b32 s15, 0x20000
  s_cmp_lt_u32 s41, 2
  s_cselect_b32 s16, s56, s58
  s_cselect_b32 s17, s57, s59
  s_mov_b32 s18, 1052672
  s_mov_b32 s19, 0x20000
  s_mov_b32 s20, s64
  s_mov_b32 s21, s65
  s_mov_b32 s22, 18350080
  s_mov_b32 s23, 0x20000
  s_mov_b32 s28, s52
  s_mov_b32 s29, s53
  s_mov_b32 s30, 524288
  s_mov_b32 s31, 0x20000
  s_mov_b32 s32, s60
  s_mov_b32 s33, s61
  s_mov_b32 s34, 4194304
  s_mov_b32 s35, 0x20000
  s_mov_b32 s36, s62
  s_mov_b32 s37, s63
  s_mov_b32 s38, 256
  s_mov_b32 s39, 0x20000
  s_lshl_b32 s48, s43, 6
  s_lshl_b32 s52, s41, 4
  s_add_u32 s48, s48, s52
  s_lshl_b32 s48, s48, 10
  s_lshl_b32 s49, s44, 7
  s_lshl_b32 s50, s41, 11
  s_lshl_b32 s51, s41, 12
  s_lshr_b32 s58, s2, 3
  s_add_u32 s52, s58, 0
  s_and_b32 s52, s52, 7
  s_lshl_b32 s53, s52, 7
  s_add_u32 s53, s53, s48
  s_add_u32 m0, s50, 0
  s_nop 0
  buffer_load_dwordx4 v16, s[4:7], s53 offen lds
  s_add_u32 m0, s50, 1024
  s_nop 0
  buffer_load_dwordx4 v17, s[4:7], s53 offen lds
  s_add_u32 s52, s58, 0
  s_and_b32 s52, s52, 7
  s_mul_i32 s52, s52, 196608
  s_add_u32 s52, s52, s49
  s_add_u32 m0, s51, 65536
  s_add_u32 s53, s52, 0
  buffer_load_dwordx4 v18, s[8:11], s53 offen lds
  s_add_u32 m0, s51, 66560
  s_add_u32 s53, s52, 12288
  buffer_load_dwordx4 v18, s[8:11], s53 offen lds
  s_add_u32 m0, s51, 67584
  s_add_u32 s53, s52, 24576
  buffer_load_dwordx4 v18, s[8:11], s53 offen lds
  s_add_u32 m0, s51, 68608
  s_add_u32 s53, s52, 36864
  buffer_load_dwordx4 v18, s[8:11], s53 offen lds
  s_add_u32 m0, s50, 81920
  s_add_u32 s53, s52, 0
  buffer_load_dwordx4 v19, s[8:11], s53 offen lds
  s_add_u32 m0, s50, 82944
  s_add_u32 s53, s52, 24576
  buffer_load_dwordx4 v19, s[8:11], s53 offen lds
  s_add_u32 s52, s58, 1
  s_and_b32 s52, s52, 7
  s_lshl_b32 s53, s52, 7
  s_add_u32 s53, s53, s48
  s_add_u32 m0, s50, 8192
  s_nop 0
  buffer_load_dwordx4 v16, s[4:7], s53 offen lds
  s_add_u32 m0, s50, 9216
  s_nop 0
  buffer_load_dwordx4 v17, s[4:7], s53 offen lds
  s_add_u32 s52, s58, 1
  s_and_b32 s52, s52, 7
  s_mul_i32 s52, s52, 196608
  s_add_u32 s52, s52, s49
  s_add_u32 m0, s51, 90112
  s_add_u32 s53, s52, 0
  buffer_load_dwordx4 v18, s[8:11], s53 offen lds
  s_add_u32 m0, s51, 91136
  s_add_u32 s53, s52, 12288
  buffer_load_dwordx4 v18, s[8:11], s53 offen lds
  s_add_u32 m0, s51, 92160
  s_add_u32 s53, s52, 24576
  buffer_load_dwordx4 v18, s[8:11], s53 offen lds
  s_add_u32 m0, s51, 93184
  s_add_u32 s53, s52, 36864
  buffer_load_dwordx4 v18, s[8:11], s53 offen lds
  s_add_u32 m0, s50, 106496
  s_add_u32 s53, s52, 0
  buffer_load_dwordx4 v19, s[8:11], s53 offen lds
  s_add_u32 m0, s50, 107520
  s_add_u32 s53, s52, 24576
  buffer_load_dwordx4 v19, s[8:11], s53 offen lds
  s_waitcnt vmcnt(8)
  s_barrier
  s_add_u32 s52, s58, 2
  s_and_b32 s52, s52, 7
  s_lshl_b32 s53, s52, 7
  s_add_u32 s53, s53, s48
  s_add_u32 m0, s50, 16384
  s_nop 0
  buffer_load_dwordx4 v16, s[4:7], s53 offen lds
  s_add_u32 m0, s50, 17408
  s_nop 0
  buffer_load_dwordx4 v17, s[4:7], s53 offen lds
  s_add_u32 s52, s58, 3
  s_and_b32 s52, s52, 7
  s_lshl_b32 s53, s52, 7
  s_add_u32 s53, s53, s48
  s_add_u32 m0, s50, 24576
  s_nop 0
  buffer_load_dwordx4 v16, s[4:7], s53 offen lds
  s_add_u32 m0, s50, 25600
  s_nop 0
  buffer_load_dwordx4 v17, s[4:7], s53 offen lds
  s_add_u32 s52, s58, 2
  s_and_b32 s52, s52, 7
  s_mul_i32 s52, s52, 196608
  s_add_u32 s52, s52, s49
  s_add_u32 m0, s51, 114688
  s_add_u32 s53, s52, 0
  buffer_load_dwordx4 v18, s[8:11], s53 offen lds
  s_add_u32 m0, s51, 115712
  s_add_u32 s53, s52, 12288
  buffer_load_dwordx4 v18, s[8:11], s53 offen lds
  s_add_u32 m0, s51, 116736
  s_add_u32 s53, s52, 24576
  buffer_load_dwordx4 v18, s[8:11], s53 offen lds
  s_add_u32 m0, s51, 117760
  s_add_u32 s53, s52, 36864
  buffer_load_dwordx4 v18, s[8:11], s53 offen lds
  s_add_u32 m0, s50, 131072
  s_add_u32 s53, s52, 0
  buffer_load_dwordx4 v19, s[8:11], s53 offen lds
  s_add_u32 m0, s50, 132096
  s_add_u32 s53, s52, 24576
  buffer_load_dwordx4 v19, s[8:11], s53 offen lds
  s_add_u32 s52, s58, 4
  s_and_b32 s52, s52, 7
  s_lshl_b32 s53, s52, 7
  s_add_u32 s53, s53, s48
  s_add_u32 m0, s50, 32768
  s_nop 0
  buffer_load_dwordx4 v16, s[4:7], s53 offen lds
  s_add_u32 m0, s50, 33792
  s_nop 0
  buffer_load_dwordx4 v17, s[4:7], s53 offen lds
  s_add_u32 s52, s58, 5
  s_and_b32 s52, s52, 7
  s_lshl_b32 s53, s52, 7
  s_add_u32 s53, s53, s48
  s_add_u32 m0, s50, 40960
  s_nop 0
  buffer_load_dwordx4 v16, s[4:7], s53 offen lds
  s_add_u32 m0, s50, 41984
  s_nop 0
  buffer_load_dwordx4 v17, s[4:7], s53 offen lds
  s_add_u32 s52, s58, 6
  s_and_b32 s52, s52, 7
  s_lshl_b32 s53, s52, 7
  s_add_u32 s53, s53, s48
  s_add_u32 m0, s50, 49152
  s_nop 0
  buffer_load_dwordx4 v16, s[4:7], s53 offen lds
  s_add_u32 m0, s50, 50176
  s_nop 0
  buffer_load_dwordx4 v17, s[4:7], s53 offen lds
  s_add_u32 s52, s58, 7
  s_and_b32 s52, s52, 7
  s_lshl_b32 s53, s52, 7
  s_add_u32 s53, s53, s48
  s_add_u32 m0, s50, 57344
  s_nop 0
  buffer_load_dwordx4 v16, s[4:7], s53 offen lds
  s_add_u32 m0, s50, 58368
  s_nop 0
  buffer_load_dwordx4 v17, s[4:7], s53 offen lds
  s_waitcnt vmcnt(18)
  s_barrier
  s_add_u32 s52, s58, 3
  s_and_b32 s52, s52, 7
  s_mul_i32 s52, s52, 196608
  s_add_u32 s52, s52, s49
  s_add_u32 m0, s51, 65536
  s_add_u32 s53, s52, 0
  buffer_load_dwordx4 v18, s[8:11], s53 offen lds
  s_add_u32 m0, s51, 66560
  s_add_u32 s53, s52, 12288
  buffer_load_dwordx4 v18, s[8:11], s53 offen lds
  s_add_u32 m0, s51, 67584
  s_add_u32 s53, s52, 24576
  buffer_load_dwordx4 v18, s[8:11], s53 offen lds
  s_add_u32 m0, s51, 68608
  s_add_u32 s53, s52, 36864
  buffer_load_dwordx4 v18, s[8:11], s53 offen lds
  s_add_u32 m0, s50, 81920
  s_add_u32 s53, s52, 0
  buffer_load_dwordx4 v19, s[8:11], s53 offen lds
  s_add_u32 m0, s50, 82944
  s_add_u32 s53, s52, 24576
  buffer_load_dwordx4 v19, s[8:11], s53 offen lds
  s_waitcnt vmcnt(14)
  s_barrier
  s_add_u32 s52, s58, 4
  s_and_b32 s52, s52, 7
  s_mul_i32 s52, s52, 196608
  s_add_u32 s52, s52, s49
  s_add_u32 m0, s51, 90112
  s_add_u32 s53, s52, 0
  buffer_load_dwordx4 v18, s[8:11], s53 offen lds
  s_add_u32 m0, s51, 91136
  s_add_u32 s53, s52, 12288
  buffer_load_dwordx4 v18, s[8:11], s53 offen lds
  s_add_u32 m0, s51, 92160
  s_add_u32 s53, s52, 24576
  buffer_load_dwordx4 v18, s[8:11], s53 offen lds
  s_add_u32 m0, s51, 93184
  s_add_u32 s53, s52, 36864
  buffer_load_dwordx4 v18, s[8:11], s53 offen lds
  s_add_u32 m0, s50, 106496
  s_add_u32 s53, s52, 0
  buffer_load_dwordx4 v19, s[8:11], s53 offen lds
  s_add_u32 m0, s50, 107520
  s_add_u32 s53, s52, 24576
  buffer_load_dwordx4 v19, s[8:11], s53 offen lds
  s_waitcnt vmcnt(6)
  s_barrier
  s_add_u32 s52, s58, 5
  s_and_b32 s52, s52, 7
  s_mul_i32 s52, s52, 196608
  s_add_u32 s52, s52, s49
  s_add_u32 m0, s51, 114688
  s_add_u32 s53, s52, 0
  buffer_load_dwordx4 v18, s[8:11], s53 offen lds
  s_add_u32 m0, s51, 115712
  s_add_u32 s53, s52, 12288
  buffer_load_dwordx4 v18, s[8:11], s53 offen lds
  s_add_u32 m0, s51, 116736
  s_add_u32 s53, s52, 24576
  buffer_load_dwordx4 v18, s[8:11], s53 offen lds
  s_add_u32 m0, s51, 117760
  s_add_u32 s53, s52, 36864
  buffer_load_dwordx4 v18, s[8:11], s53 offen lds
  s_add_u32 m0, s50, 131072
  s_add_u32 s53, s52, 0
  buffer_load_dwordx4 v19, s[8:11], s53 offen lds
  s_add_u32 m0, s50, 132096
  s_add_u32 s53, s52, 24576
  buffer_load_dwordx4 v19, s[8:11], s53 offen lds
  s_waitcnt vmcnt(6)
  s_barrier
  s_add_u32 s52, s58, 6
  s_and_b32 s52, s52, 7
  s_mul_i32 s52, s52, 196608
  s_add_u32 s52, s52, s49
  s_add_u32 m0, s51, 65536
  s_add_u32 s53, s52, 0
  buffer_load_dwordx4 v18, s[8:11], s53 offen lds
  s_add_u32 m0, s51, 66560
  s_add_u32 s53, s52, 12288
  buffer_load_dwordx4 v18, s[8:11], s53 offen lds
  s_add_u32 m0, s51, 67584
  s_add_u32 s53, s52, 24576
  buffer_load_dwordx4 v18, s[8:11], s53 offen lds
  s_add_u32 m0, s51, 68608
  s_add_u32 s53, s52, 36864
  buffer_load_dwordx4 v18, s[8:11], s53 offen lds
  s_add_u32 m0, s50, 81920
  s_add_u32 s53, s52, 0
  buffer_load_dwordx4 v19, s[8:11], s53 offen lds
  s_add_u32 m0, s50, 82944
  s_add_u32 s53, s52, 24576
  buffer_load_dwordx4 v19, s[8:11], s53 offen lds
  s_waitcnt vmcnt(6)
  s_barrier
  s_add_u32 s52, s58, 7
  s_and_b32 s52, s52, 7
  s_mul_i32 s52, s52, 196608
  s_add_u32 s52, s52, s49
  s_add_u32 m0, s51, 90112
  s_add_u32 s53, s52, 0
  buffer_load_dwordx4 v18, s[8:11], s53 offen lds
  s_add_u32 m0, s51, 91136
  s_add_u32 s53, s52, 12288
  buffer_load_dwordx4 v18, s[8:11], s53 offen lds
  s_add_u32 m0, s51, 92160
  s_add_u32 s53, s52, 24576
  buffer_load_dwordx4 v18, s[8:11], s53 offen lds
  s_add_u32 m0, s51, 93184
  s_add_u32 s53, s52, 36864
  buffer_load_dwordx4 v18, s[8:11], s53 offen lds
  s_add_u32 m0, s50, 106496
  s_add_u32 s53, s52, 0
  buffer_load_dwordx4 v19, s[8:11], s53 offen lds
  s_add_u32 m0, s50, 107520
  s_add_u32 s53, s52, 24576
  buffer_load_dwordx4 v19, s[8:11], s53 offen lds
  s_waitcnt vmcnt(6)
  s_barrier
  s_waitcnt vmcnt(0)
  s_barrier
  s_setprio 0
  v_and_b32 v4, 15, v3
  v_lshrrev_b32 v5, 4, v3
  v_cvt_f32_u32 v4, v4
  v_cvt_f32_u32 v5, v5
  v_add_f32 v6, 0x0, v4
  v_mul_f32 v6, 0x3d000000, v6
  v_mul_f32 v7, 4.0, v5
  v_mul_f32 v7, v7, v6
  v_mov_b32 v8, 0x0
  v_fma_f32 v8, v6, v8, v7
  v_cos_f32 v10, v8
  v_sin_f32 v12, v8
  v_mov_b32 v9, 0x3f800000
  v_fma_f32 v9, v6, v9, v7
  v_cos_f32 v11, v9
  v_sin_f32 v13, v9
  v_cvt_pk_bf16_f32 v88, v10, v11
  v_cvt_pk_bf16_f32 v92, v12, v13
  v_cvt_pk_bf16_f32 v96, -v12, -v13
  v_mov_b32 v8, 0x40000000
  v_fma_f32 v8, v6, v8, v7
  v_cos_f32 v10, v8
  v_sin_f32 v12, v8
  v_mov_b32 v9, 0x40400000
  v_fma_f32 v9, v6, v9, v7
  v_cos_f32 v11, v9
  v_sin_f32 v13, v9
  v_cvt_pk_bf16_f32 v89, v10, v11
  v_cvt_pk_bf16_f32 v93, v12, v13
  v_cvt_pk_bf16_f32 v97, -v12, -v13
  v_mov_b32 v8, 0x41800000
  v_fma_f32 v8, v6, v8, v7
  v_cos_f32 v10, v8
  v_sin_f32 v12, v8
  v_mov_b32 v9, 0x41880000
  v_fma_f32 v9, v6, v9, v7
  v_cos_f32 v11, v9
  v_sin_f32 v13, v9
  v_cvt_pk_bf16_f32 v90, v10, v11
  v_cvt_pk_bf16_f32 v94, v12, v13
  v_cvt_pk_bf16_f32 v98, -v12, -v13
  v_mov_b32 v8, 0x41900000
  v_fma_f32 v8, v6, v8, v7
  v_cos_f32 v10, v8
  v_sin_f32 v12, v8
  v_mov_b32 v9, 0x41980000
  v_fma_f32 v9, v6, v9, v7
  v_cos_f32 v11, v9
  v_sin_f32 v13, v9
  v_cvt_pk_bf16_f32 v91, v10, v11
  v_cvt_pk_bf16_f32 v95, v12, v13
  v_cvt_pk_bf16_f32 v99, -v12, -v13
  v_and_b32 v4, 15, v3
  v_lshrrev_b32 v5, 4, v3
  v_cvt_f32_u32 v4, v4
  v_cvt_f32_u32 v5, v5
  v_add_f32 v6, 0x41800000, v4
  v_mul_f32 v6, 0x3d000000, v6
  v_mul_f32 v7, 4.0, v5
  v_mul_f32 v7, v7, v6
  v_mov_b32 v8, 0x0
  v_fma_f32 v8, v6, v8, v7
  v_cos_f32 v10, v8
  v_sin_f32 v12, v8
  v_mov_b32 v9, 0x3f800000
  v_fma_f32 v9, v6, v9, v7
  v_cos_f32 v11, v9
  v_sin_f32 v13, v9
  v_cvt_pk_bf16_f32 v100, v10, v11
  v_cvt_pk_bf16_f32 v104, v12, v13
  v_cvt_pk_bf16_f32 v108, -v12, -v13
  v_mov_b32 v8, 0x40000000
  v_fma_f32 v8, v6, v8, v7
  v_cos_f32 v10, v8
  v_sin_f32 v12, v8
  v_mov_b32 v9, 0x40400000
  v_fma_f32 v9, v6, v9, v7
  v_cos_f32 v11, v9
  v_sin_f32 v13, v9
  v_cvt_pk_bf16_f32 v101, v10, v11
  v_cvt_pk_bf16_f32 v105, v12, v13
  v_cvt_pk_bf16_f32 v109, -v12, -v13
  v_mov_b32 v8, 0x41800000
  v_fma_f32 v8, v6, v8, v7
  v_cos_f32 v10, v8
  v_sin_f32 v12, v8
  v_mov_b32 v9, 0x41880000
  v_fma_f32 v9, v6, v9, v7
  v_cos_f32 v11, v9
  v_sin_f32 v13, v9
  v_cvt_pk_bf16_f32 v102, v10, v11
  v_cvt_pk_bf16_f32 v106, v12, v13
  v_cvt_pk_bf16_f32 v110, -v12, -v13
  v_mov_b32 v8, 0x41900000
  v_fma_f32 v8, v6, v8, v7
  v_cos_f32 v10, v8
  v_sin_f32 v12, v8
  v_mov_b32 v9, 0x41980000
  v_fma_f32 v9, v6, v9, v7
  v_cos_f32 v11, v9
  v_sin_f32 v13, v9
  v_cvt_pk_bf16_f32 v103, v10, v11
  v_cvt_pk_bf16_f32 v107, v12, v13
  v_cvt_pk_bf16_f32 v111, -v12, -v13
  v_and_b32 v4, 15, v3
  v_lshrrev_b32 v5, 4, v3
  v_cvt_f32_u32 v4, v4
  v_cvt_f32_u32 v5, v5
  v_cvt_f32_u32 v6, v2
  v_mul_f32 v6, 0x41800000, v6
  v_add_f32 v6, v6, v4
  v_mul_f32 v6, 0x3c800000, v6
  v_mul_f32 v7, 0x41000000, v5
  v_mul_f32 v7, v7, v6
  v_mov_b32 v8, 0x0
  v_fma_f32 v8, v6, v8, v7
  v_fract_f32 v8, v8
  v_cos_f32 v10, v8
  v_sin_f32 v12, v8
  v_mov_b32 v9, 0x3f800000
  v_fma_f32 v9, v6, v9, v7
  v_fract_f32 v9, v9
  v_cos_f32 v11, v9
  v_sin_f32 v13, v9
  v_cvt_pk_bf16_f32 v112, v10, v11
  v_cvt_pk_bf16_f32 v116, v12, v13
  v_cvt_pk_bf16_f32 v120, -v12, -v13
  v_mov_b32 v8, 0x40000000
  v_fma_f32 v8, v6, v8, v7
  v_fract_f32 v8, v8
  v_cos_f32 v10, v8
  v_sin_f32 v12, v8
  v_mov_b32 v9, 0x40400000
  v_fma_f32 v9, v6, v9, v7
  v_fract_f32 v9, v9
  v_cos_f32 v11, v9
  v_sin_f32 v13, v9
  v_cvt_pk_bf16_f32 v113, v10, v11
  v_cvt_pk_bf16_f32 v117, v12, v13
  v_cvt_pk_bf16_f32 v121, -v12, -v13
  v_mov_b32 v8, 0x40800000
  v_fma_f32 v8, v6, v8, v7
  v_fract_f32 v8, v8
  v_cos_f32 v10, v8
  v_sin_f32 v12, v8
  v_mov_b32 v9, 0x40a00000
  v_fma_f32 v9, v6, v9, v7
  v_fract_f32 v9, v9
  v_cos_f32 v11, v9
  v_sin_f32 v13, v9
  v_cvt_pk_bf16_f32 v114, v10, v11
  v_cvt_pk_bf16_f32 v118, v12, v13
  v_cvt_pk_bf16_f32 v122, -v12, -v13
  v_mov_b32 v8, 0x40c00000
  v_fma_f32 v8, v6, v8, v7
  v_fract_f32 v8, v8
  v_cos_f32 v10, v8
  v_sin_f32 v12, v8
  v_mov_b32 v9, 0x40e00000
  v_fma_f32 v9, v6, v9, v7
  v_fract_f32 v9, v9
  v_cos_f32 v11, v9
  v_sin_f32 v13, v9
  v_cvt_pk_bf16_f32 v115, v10, v11
  v_cvt_pk_bf16_f32 v119, v12, v13
  v_cvt_pk_bf16_f32 v123, -v12, -v13
  v_and_b32 v4, 15, v3
  v_lshrrev_b32 v5, 4, v3
  v_cvt_f32_u32 v4, v4
  v_cvt_f32_u32 v5, v5
  v_cvt_f32_u32 v6, v2
  v_mul_f32 v6, 0x41800000, v6
  v_add_f32 v6, v6, v4
  v_mul_f32 v6, 0x3c800000, v6
  v_mul_f32 v7, 0x41000000, v5
  v_mul_f32 v7, v7, v6
  v_mov_b32 v8, 0x42000000
  v_fma_f32 v8, v6, v8, v7
  v_fract_f32 v8, v8
  v_cos_f32 v10, v8
  v_sin_f32 v12, v8
  v_mov_b32 v9, 0x42040000
  v_fma_f32 v9, v6, v9, v7
  v_fract_f32 v9, v9
  v_cos_f32 v11, v9
  v_sin_f32 v13, v9
  v_cvt_pk_bf16_f32 v124, v10, v11
  v_cvt_pk_bf16_f32 v128, v12, v13
  v_cvt_pk_bf16_f32 v132, -v12, -v13
  v_mov_b32 v8, 0x42080000
  v_fma_f32 v8, v6, v8, v7
  v_fract_f32 v8, v8
  v_cos_f32 v10, v8
  v_sin_f32 v12, v8
  v_mov_b32 v9, 0x420c0000
  v_fma_f32 v9, v6, v9, v7
  v_fract_f32 v9, v9
  v_cos_f32 v11, v9
  v_sin_f32 v13, v9
  v_cvt_pk_bf16_f32 v125, v10, v11
  v_cvt_pk_bf16_f32 v129, v12, v13
  v_cvt_pk_bf16_f32 v133, -v12, -v13
  v_mov_b32 v8, 0x42100000
  v_fma_f32 v8, v6, v8, v7
  v_fract_f32 v8, v8
  v_cos_f32 v10, v8
  v_sin_f32 v12, v8
  v_mov_b32 v9, 0x42140000
  v_fma_f32 v9, v6, v9, v7
  v_fract_f32 v9, v9
  v_cos_f32 v11, v9
  v_sin_f32 v13, v9
  v_cvt_pk_bf16_f32 v126, v10, v11
  v_cvt_pk_bf16_f32 v130, v12, v13
  v_cvt_pk_bf16_f32 v134, -v12, -v13
  v_mov_b32 v8, 0x42180000
  v_fma_f32 v8, v6, v8, v7
  v_fract_f32 v8, v8
  v_cos_f32 v10, v8
  v_sin_f32 v12, v8
  v_mov_b32 v9, 0x421c0000
  v_fma_f32 v9, v6, v9, v7
  v_fract_f32 v9, v9
  v_cos_f32 v11, v9
  v_sin_f32 v13, v9
  v_cvt_pk_bf16_f32 v127, v10, v11
  v_cvt_pk_bf16_f32 v131, v12, v13
  v_cvt_pk_bf16_f32 v135, -v12, -v13
  v_and_b32 v4, 15, v3
  v_lshrrev_b32 v5, 4, v3
  v_cvt_f32_u32 v4, v4
  v_cvt_f32_u32 v5, v5
  v_cvt_f32_u32 v6, v2
  v_mul_f32 v6, 0x41800000, v6
  v_mul_f32 v7, 4.0, v5
  v_add_f32 v8, 0x0, v4
  v_mul_f32 v8, 0x3a000000, v8
  v_add_f32 v9, v6, v7
  v_add_f32 v10, 0x0, v9
  v_mul_f32 v10, v10, v8
  v_cos_f32 v136, v10
  v_sin_f32 v144, v10
  v_add_f32 v10, 0x3f800000, v9
  v_mul_f32 v10, v10, v8
  v_cos_f32 v137, v10
  v_sin_f32 v145, v10
  v_add_f32 v10, 0x40000000, v9
  v_mul_f32 v10, v10, v8
  v_cos_f32 v138, v10
  v_sin_f32 v146, v10
  v_add_f32 v10, 0x40400000, v9
  v_mul_f32 v10, v10, v8
  v_cos_f32 v139, v10
  v_sin_f32 v147, v10
  v_add_f32 v8, v6, v4
  v_mul_f32 v8, 0x3a000000, v8
  v_add_f32 v9, 0x0, v7
  v_add_f32 v10, 0x0, v9
  v_mul_f32 v10, v10, v8
  v_cos_f32 v152, v10
  v_sin_f32 v160, v10
  v_add_f32 v10, 0x3f800000, v9
  v_mul_f32 v10, v10, v8
  v_cos_f32 v153, v10
  v_sin_f32 v161, v10
  v_add_f32 v10, 0x40000000, v9
  v_mul_f32 v10, v10, v8
  v_cos_f32 v154, v10
  v_sin_f32 v162, v10
  v_add_f32 v10, 0x40400000, v9
  v_mul_f32 v10, v10, v8
  v_cos_f32 v155, v10
  v_sin_f32 v163, v10
  v_and_b32 v4, 15, v3
  v_lshrrev_b32 v5, 4, v3
  v_cvt_f32_u32 v4, v4
  v_cvt_f32_u32 v5, v5
  v_cvt_f32_u32 v6, v2
  v_mul_f32 v6, 0x41800000, v6
  v_mul_f32 v7, 4.0, v5
  v_add_f32 v8, 0x41800000, v4
  v_mul_f32 v8, 0x3a000000, v8
  v_add_f32 v9, v6, v7
  v_add_f32 v10, 0x0, v9
  v_mul_f32 v10, v10, v8
  v_cos_f32 v140, v10
  v_sin_f32 v148, v10
  v_add_f32 v10, 0x3f800000, v9
  v_mul_f32 v10, v10, v8
  v_cos_f32 v141, v10
  v_sin_f32 v149, v10
  v_add_f32 v10, 0x40000000, v9
  v_mul_f32 v10, v10, v8
  v_cos_f32 v142, v10
  v_sin_f32 v150, v10
  v_add_f32 v10, 0x40400000, v9
  v_mul_f32 v10, v10, v8
  v_cos_f32 v143, v10
  v_sin_f32 v151, v10
  v_add_f32 v8, v6, v4
  v_mul_f32 v8, 0x3a000000, v8
  v_add_f32 v9, 0x41800000, v7
  v_add_f32 v10, 0x0, v9
  v_mul_f32 v10, v10, v8
  v_cos_f32 v156, v10
  v_sin_f32 v164, v10
  v_add_f32 v10, 0x3f800000, v9
  v_mul_f32 v10, v10, v8
  v_cos_f32 v157, v10
  v_sin_f32 v165, v10
  v_add_f32 v10, 0x40000000, v9
  v_mul_f32 v10, v10, v8
  v_cos_f32 v158, v10
  v_sin_f32 v166, v10
  v_add_f32 v10, 0x40400000, v9
  v_mul_f32 v10, v10, v8
  v_cos_f32 v159, v10
  v_sin_f32 v167, v10
  v_mov_b32 v4, 159956
  ds_read_b32 v5, v4
  s_waitcnt lgkmcnt(0)
  v_readfirstlane_b32 s42, v5
  s_and_b32 s48, s2, 7
  s_lshl_b32 s48, s48, 5
  s_lshr_b32 s49, s2, 3
  s_add_u32 s46, s48, s49
  s_mov_b32 s47, 0
  v_lshrrev_b32 v4, 4, v3
  v_and_b32 v5, 15, v3
  v_lshl_add_u32 v8, v4, 6, v5
  s_movk_i32 s48, 8320
  v_mul_lo_u32 v8, v8, s48
  v_mul_lo_u32 v9, v3, s48
  v_mul_u32_u24 v7, 144, v5
  v_lshl_add_u32 v6, v4, 3, v7
  v_lshl_add_u32 v6, v2, 5, v6
  v_lshl_add_u32 v7, v4, 4, v7
  s_and_b32 s57, s2, 1
  v_lshl_add_u32 v14, v2, 6, v3
  v_lshrrev_b32 v10, 1, v14
  v_lshlrev_b32 v11, 5, v10
  v_lshrrev_b32 v10, 3, v10
  v_lshl_add_u32 v11, v10, 4, v11
  v_and_b32 v10, 1, v14
  v_lshl_add_u32 v11, v10, 4, v11
  v_add_u32 v15, 148480, v11
  v_and_b32 v11, 15, v3
  v_lshrrev_b32 v12, 2, v11
  v_mul_u32_u24 v12, 576, v12
  v_and_b32 v11, 3, v11
  v_lshlrev_b32 v11, 3, v11
  v_lshrrev_b32 v13, 4, v3
  v_lshlrev_b32 v13, 5, v13
  v_add3_u32 v11, v11, v12, v13
  v_lshl_add_u32 v11, v2, 7, v11
  v_add_u32 v16, 139264, v11
  v_lshlrev_b32 v17, 4, v14
  v_subrev_u32 v18, s57, v14
  v_lshlrev_b32 v18, 5, v18
  s_mul_i32 s54, s2, 8320
  s_add_u32 s55, s54, 8388608
  s_add_u32 s56, s54, 11534336
  v_mov_b32 v10, 159984
L_lw_55:
  ds_read_b32 v11, v10
  s_waitcnt lgkmcnt(0)
  v_readfirstlane_b32 s70, v11
  s_nop 0
  s_cmp_ge_u32 s70, 8
  s_cbranch_scc1 L_lwok_56
  s_add_u32 s71, s71, 1
  s_cmp_gt_u32 s71, 131072
  s_cbranch_scc1 L_lwok_56
  s_sleep 1
  s_branch L_lw_55
L_lwok_56:
  v_mov_b32 v10, 160000
L_lw_57:
  ds_read_b32 v11, v10
  s_waitcnt lgkmcnt(0)
  v_readfirstlane_b32 s70, v11
  s_nop 0
  s_cmp_ge_u32 s70, 8
  s_cbranch_scc1 L_lwok_58
  s_add_u32 s71, s71, 1
  s_cmp_gt_u32 s71, 131072
  s_cbranch_scc1 L_lwok_58
  s_sleep 2
  s_branch L_lw_57
L_lwok_58:
  s_setprio 3
  ds_read_b128 v[20:23], v15
  ds_read_b128 v[24:27], v15 offset:4352
  ds_read_b64_tr_b16 v[28:29], v16 offset:0
  ds_read_b64_tr_b16 v[30:31], v16 offset:2304
  ds_read_b64_tr_b16 v[32:33], v16 offset:4608
  ds_read_b64_tr_b16 v[34:35], v16 offset:6912
  s_waitcnt lgkmcnt(0)
  buffer_store_dwordx4 v[20:23], v17, s[20:23], s55 offen sc1
  s_add_u32 s53, s55, 4096
  buffer_store_dwordx4 v[24:27], v17, s[20:23], s53 offen sc1
  s_cmp_eq_u32 s57, 0
  s_cbranch_scc1 L_sh_59
  s_cmp_lg_u32 s41, 0
  s_cbranch_scc1 L_sh_59
  s_mov_b32 exec_lo, 0xfffffffe
L_sh_59:
  buffer_store_dwordx4 v[28:31], v18, s[20:23], s56 offen sc1
  buffer_store_dwordx4 v[32:35], v18, s[20:23], s56 offen offset:16 sc1
  s_mov_b64 exec, -1
  s_cmp_lg_u32 s41, 0
  s_cbranch_scc1 L_nyq_60
  s_cmp_eq_u32 s57, 0
  s_cselect_b32 exec_lo, 0xffff, -1
  s_mov_b32 exec_hi, 0
  v_and_b32 v10, 15, v3
  v_lshrrev_b32 v12, 4, v3
  v_mul_u32_u24 v11, 576, v10
  v_lshl_add_u32 v11, v12, 1, v11
  v_add_u32 v11, 139776, v11
  ds_read_u16 v36, v11
  v_add_u32 v12, 256, v12
  v_subrev_u32 v12, s57, v12
  v_lshlrev_b32 v12, 5, v12
  v_lshl_add_u32 v12, v10, 1, v12
  s_waitcnt lgkmcnt(0)
  buffer_store_short v36, v12, s[20:23], s56 offen sc1
  s_mov_b64 exec, -1
L_nyq_60:
  s_waitcnt vmcnt(0)
  s_mov_b64 exec, 1
  v_mov_b32 v10, 159988
  v_mov_b32 v11, 1
  ds_add_rtn_u32 v11, v10, v11
  s_waitcnt lgkmcnt(0)
  v_readfirstlane_b32 s70, v11
  s_nop 0
  s_cmp_lg_u32 s70, 3
  s_cbranch_scc1 L_arr_61
  s_and_b32 s70, s2, 7
  s_cmp_eq_u32 s70, 0
  s_cselect_b32 s69, 32, 32
  s_lshl_b32 s70, s70, 7
  s_add_u32 s70, s70, 17571840
  v_mov_b32 v12, 0
  v_mov_b32 v13, 1
  s_mov_b64 exec, 1
  buffer_atomic_add v13, v12, s[20:23], s70 offen sc0 sc1
  s_waitcnt vmcnt(0)
  v_readfirstlane_b32 s70, v13
  s_nop 0
  s_add_u32 s70, s70, 1
  s_cmp_lg_u32 s70, s69
  s_cbranch_scc1 L_tree_62
  s_mov_b32 s70, 17574912
  v_mov_b32 v13, 1
  buffer_atomic_add v13, v12, s[20:23], s70 offen sc0 sc1
  s_waitcnt vmcnt(0)
  v_readfirstlane_b32 s70, v13
  s_nop 0
  s_cmp_lg_u32 s70, 7
  s_cbranch_scc1 L_tree_62
  s_mov_b64 exec, 0xff
  v_lshlrev_b32 v12, 7, v3
  v_mov_b32 v13, s42
  s_mov_b32 s70, 17575936
  buffer_store_dword v13, v12, s[20:23], s70 offen sc1
L_tree_62:
  s_mov_b64 exec, -1
  s_mov_b64 exec, 1
L_arr_61:
  s_mov_b64 exec, -1
  s_setprio 0
  v_lshrrev_b32 v10, 3, v3
  v_and_b32 v11, 6, v10
  v_and_b32 v12, 7, v3
  v_xor_b32 v11, v11, v12
  v_lshlrev_b32 v11, 4, v11
  v_lshl_add_u32 v13, v10, 10, v11
  s_lshr_b32 s48, s2, 5
  s_lshl_b32 s48, s48, 7
  s_lshl_b32 s49, s41, 17
  s_add_u32 s48, s48, s49
  s_lshl_b32 s49, s41, 14
  s_add_u32 m0, s49, 0
  s_add_u32 s50, s48, 0
  buffer_load_dwordx4 v13, s[28:31], s50 offen lds
  s_add_u32 m0, s49, 1024
  s_add_u32 s50, s48, 8192
  buffer_load_dwordx4 v13, s[28:31], s50 offen lds
  s_add_u32 m0, s49, 2048
  s_add_u32 s50, s48, 16384
  buffer_load_dwordx4 v13, s[28:31], s50 offen lds
  s_add_u32 m0, s49, 3072
  s_add_u32 s50, s48, 24576
  buffer_load_dwordx4 v13, s[28:31], s50 offen lds
  s_waitcnt vmcnt(0)
  s_add_u32 m0, s49, 4096
  s_add_u32 s50, s48, 32768
  buffer_load_dwordx4 v13, s[28:31], s50 offen lds
  s_add_u32 m0, s49, 5120
  s_add_u32 s50, s48, 40960
  buffer_load_dwordx4 v13, s[28:31], s50 offen lds
  s_add_u32 m0, s49, 6144
  s_add_u32 s50, s48, 49152
  buffer_load_dwordx4 v13, s[28:31], s50 offen lds
  s_add_u32 m0, s49, 7168
  s_add_u32 s50, s48, 57344
  buffer_load_dwordx4 v13, s[28:31], s50 offen lds
  s_waitcnt vmcnt(0)
  s_add_u32 m0, s49, 8192
  s_add_u32 s50, s48, 65536
  buffer_load_dwordx4 v13, s[28:31], s50 offen lds
  s_add_u32 m0, s49, 9216
  s_add_u32 s50, s48, 73728
  buffer_load_dwordx4 v13, s[28:31], s50 offen lds
  s_add_u32 m0, s49, 10240
  s_add_u32 s50, s48, 81920
  buffer_load_dwordx4 v13, s[28:31], s50 offen lds
  s_add_u32 m0, s49, 11264
  s_add_u32 s50, s48, 90112
  buffer_load_dwordx4 v13, s[28:31], s50 offen lds
  s_waitcnt vmcnt(0)
  s_add_u32 m0, s49, 12288
  s_add_u32 s50, s48, 98304
  buffer_load_dwordx4 v13, s[28:31], s50 offen lds
  s_add_u32 m0, s49, 13312
  s_add_u32 s50, s48, 106496
  buffer_load_dwordx4 v13, s[28:31], s50 offen lds
  s_add_u32 m0, s49, 14336
  s_add_u32 s50, s48, 114688
  buffer_load_dwordx4 v13, s[28:31], s50 offen lds
  s_add_u32 m0, s49, 15360
  s_add_u32 s50, s48, 122880
  buffer_load_dwordx4 v13, s[28:31], s50 offen lds
  s_waitcnt vmcnt(0)
  s_waitcnt vmcnt(0)
  s_mov_b64 exec, 1
  v_mov_b32 v10, 159996
  v_mov_b32 v11, 1
  ds_add_u32 v10, v11
  s_mov_b64 exec, -1
  s_cmp_lg_u32 s40, 8
  s_cbranch_scc1 L_ow_63
  s_and_b32 s69, s2, 7
  s_lshl_b32 s69, s69, 7
  s_add_u32 s69, s69, 17575936
  v_mov_b32 v10, 0
L_pg_65:
  buffer_load_dword v11, v10, s[20:23], s69 offen sc1
  s_waitcnt vmcnt(0)
  v_readfirstlane_b32 s70, v11
  s_nop 0
  s_cmp_eq_u32 s70, s42
  s_cbranch_scc1 L_pgok_66
  s_add_u32 s71, s71, 1
  s_cmp_gt_u32 s71, 131072
  s_cbranch_scc1 L_pgok_66
  s_sleep 4
  s_branch L_pg_65
L_pgok_66:
  s_mov_b64 exec, 1
  v_mov_b32 v10, 159964
  v_mov_b32 v11, 1
  ds_write_b32 v10, v11
  s_mov_b64 exec, -1
  s_branch L_owd_64
L_ow_63:
  v_mov_b32 v10, 159964
L_lw_67:
  ds_read_b32 v11, v10
  s_waitcnt lgkmcnt(0)
  v_readfirstlane_b32 s70, v11
  s_nop 0
  s_cmp_ge_u32 s70, 1
  s_cbranch_scc1 L_lwok_68
  s_add_u32 s71, s71, 1
  s_cmp_gt_u32 s71, 131072
  s_cbranch_scc1 L_lwok_68
  s_sleep 4
  s_branch L_lw_67
L_lwok_68:
L_owd_64:
  v_mov_b32 v10, 159940
L_lw_69:
  ds_read_b32 v11, v10
  s_waitcnt lgkmcnt(0)
  v_readfirstlane_b32 s70, v11
  s_nop 0
  s_cmp_ge_u32 s70, 4
  s_cbranch_scc1 L_lwok_70
  s_add_u32 s71, s71, 1
  s_cmp_gt_u32 s71, 131072
  s_cbranch_scc1 L_lwok_70
  s_branch L_lw_69
L_lwok_70:
L_b2:
  s_lshl_b32 s48, s46, 5
  s_mul_i32 s49, s41, 133120
  s_add_u32 s49, s49, s48
  s_add_u32 s50, s49, 8388608
  s_add_u32 s52, s49, 14680064
  s_mul_i32 s51, s41, 532480
  s_add_u32 s51, s51, s48
  s_add_u32 s51, s51, 11534336
  buffer_load_dwordx4 v[64:67], v8, s[20:23], s50 offen sc1
  s_waitcnt vmcnt(0)
  buffer_load_dwordx4 v[68:71], v8, s[20:23], s50 offen offset:16 sc1
  s_waitcnt vmcnt(0)
  s_setprio 3
  v_mfma_f32_16x16x32_bf16 v[48:51], v[64:67], v[88:91], 0
  v_mfma_f32_16x16x32_bf16 v[52:55], v[68:71], v[88:91], 0
  v_mfma_f32_16x16x32_bf16 v[56:59], v[64:67], v[100:103], 0
  v_mfma_f32_16x16x32_bf16 v[60:63], v[68:71], v[100:103], 0
  v_mfma_f32_16x16x32_bf16 v[48:51], v[68:71], v[92:95], v[48:51]
  v_mfma_f32_16x16x32_bf16 v[52:55], v[64:67], v[96:99], v[52:55]
  v_mfma_f32_16x16x32_bf16 v[56:59], v[68:71], v[104:107], v[56:59]
  v_mfma_f32_16x16x32_bf16 v[60:63], v[64:67], v[108:111], v[60:63]
  v_add_u32 v14, 114688, v6
  s_nop 3
  v_mul_f32 v10, v48, v136
  v_mul_f32 v12, v52, v136
  v_fma_f32 v10, v52, v144, v10
  v_fma_f32 v12, -v48, v144, v12
  v_mul_f32 v11, v49, v137
  v_mul_f32 v13, v53, v137
  v_fma_f32 v11, v53, v145, v11
  v_fma_f32 v13, -v49, v145, v13
  v_cvt_pk_bf16_f32 v80, v10, v11
  v_cvt_pk_bf16_f32 v82, v12, v13
  v_mul_f32 v10, v50, v138
  v_mul_f32 v12, v54, v138
  v_fma_f32 v10, v54, v146, v10
  v_fma_f32 v12, -v50, v146, v12
  v_mul_f32 v11, v51, v139
  v_mul_f32 v13, v55, v139
  v_fma_f32 v11, v55, v147, v11
  v_fma_f32 v13, -v51, v147, v13
  v_cvt_pk_bf16_f32 v81, v10, v11
  v_cvt_pk_bf16_f32 v83, v12, v13
  ds_write_b64 v14, v[80:81] offset:0
  ds_write_b64 v14, v[82:83] offset:4608
  v_mul_f32 v10, v56, v140
  v_mul_f32 v12, v60, v140
  v_fma_f32 v10, v60, v148, v10
  v_fma_f32 v12, -v56, v148, v12
  v_mul_f32 v11, v57, v141
  v_mul_f32 v13, v61, v141
  v_fma_f32 v11, v61, v149, v11
  v_fma_f32 v13, -v57, v149, v13
  v_cvt_pk_bf16_f32 v84, v10, v11
  v_cvt_pk_bf16_f32 v86, v12, v13
  v_mul_f32 v10, v58, v142
  v_mul_f32 v12, v62, v142
  v_fma_f32 v10, v62, v150, v10
  v_fma_f32 v12, -v58, v150, v12
  v_mul_f32 v11, v59, v143
  v_mul_f32 v13, v63, v143
  v_fma_f32 v11, v63, v151, v11
  v_fma_f32 v13, -v59, v151, v13
  v_cvt_pk_bf16_f32 v85, v10, v11
  v_cvt_pk_bf16_f32 v87, v12, v13
  ds_write_b64 v14, v[84:85] offset:2304
  ds_write_b64 v14, v[86:87] offset:6912
  buffer_load_dwordx4 v[72:75], v9, s[20:23], s51 offen sc1
  s_waitcnt vmcnt(0)
  buffer_load_dwordx4 v[76:79], v9, s[20:23], s51 offen offset:16 sc1
  s_cmp_lg_u32 s46, 0
  s_cbranch_scc1 L_w256_71
  s_add_u32 s53, s51, 8192
  buffer_load_dwordx4 v[80:83], v9, s[20:23], s53 offen sc1
  buffer_load_dwordx4 v[84:87], v9, s[20:23], s53 offen offset:16 sc1
L_w256_71:
  s_waitcnt lgkmcnt(0)
  s_mov_b64 exec, 1
  v_mov_b32 v12, 159992
  v_mov_b32 v13, 1
  ds_add_u32 v12, v13
  s_mov_b64 exec, -1
  s_setprio 0
  s_add_u32 s47, s47, 4
  v_mov_b32 v12, 159992
L_lw_72:
  ds_read_b32 v13, v12
  s_waitcnt lgkmcnt(0)
  v_readfirstlane_b32 s70, v13
  s_nop 0
  s_cmp_ge_u32 s70, s47
  s_cbranch_scc1 L_lwok_73
  s_add_u32 s71, s71, 1
  s_cmp_gt_u32 s71, 131072
  s_cbranch_scc1 L_lwok_73
  s_sleep 1
  s_branch L_lw_72
L_lwok_73:
  s_setprio 3
  v_add_u32 v15, 114688, v7
  ds_read_b128 v[16:19], v15 offset:0
  ds_read_b128 v[32:35], v15 offset:4608
  ds_read_b128 v[20:23], v15 offset:64
  ds_read_b128 v[36:39], v15 offset:4672
  ds_read_b128 v[24:27], v15 offset:2304
  ds_read_b128 v[40:43], v15 offset:6912
  ds_read_b128 v[28:31], v15 offset:2368
  ds_read_b128 v[44:47], v15 offset:6976
  s_waitcnt lgkmcnt(0)
  v_mfma_f32_16x16x32_bf16 v[48:51], v[112:115], v[16:19], 0
  v_mfma_f32_16x16x32_bf16 v[52:55], v[112:115], v[32:35], 0
  v_mfma_f32_16x16x32_bf16 v[56:59], v[112:115], v[24:27], 0
  v_mfma_f32_16x16x32_bf16 v[60:63], v[112:115], v[40:43], 0
  v_mfma_f32_16x16x32_bf16 v[48:51], v[116:119], v[32:35], v[48:51]
  v_mfma_f32_16x16x32_bf16 v[52:55], v[120:123], v[16:19], v[52:55]
  v_mfma_f32_16x16x32_bf16 v[56:59], v[116:119], v[40:43], v[56:59]
  v_mfma_f32_16x16x32_bf16 v[60:63], v[120:123], v[24:27], v[60:63]
  v_mfma_f32_16x16x32_bf16 v[48:51], v[124:127], v[20:23], v[48:51]
  v_mfma_f32_16x16x32_bf16 v[52:55], v[124:127], v[36:39], v[52:55]
  v_mfma_f32_16x16x32_bf16 v[56:59], v[124:127], v[28:31], v[56:59]
  v_mfma_f32_16x16x32_bf16 v[60:63], v[124:127], v[44:47], v[60:63]
  v_mfma_f32_16x16x32_bf16 v[48:51], v[128:131], v[36:39], v[48:51]
  v_mfma_f32_16x16x32_bf16 v[52:55], v[132:135], v[20:23], v[52:55]
  v_mfma_f32_16x16x32_bf16 v[56:59], v[128:131], v[44:47], v[56:59]
  v_mfma_f32_16x16x32_bf16 v[60:63], v[132:135], v[28:31], v[60:63]
  s_waitcnt vmcnt(0)
  s_nop 3
  v_lshlrev_b32 v16, 16, v72
  v_and_b32 v17, 0xffff0000, v72
  v_lshlrev_b32 v24, 16, v76
  v_and_b32 v25, 0xffff0000, v76
  v_lshlrev_b32 v18, 16, v73
  v_and_b32 v19, 0xffff0000, v73
  v_lshlrev_b32 v26, 16, v77
  v_and_b32 v27, 0xffff0000, v77
  v_lshlrev_b32 v20, 16, v74
  v_and_b32 v21, 0xffff0000, v74
  v_lshlrev_b32 v28, 16, v78
  v_and_b32 v29, 0xffff0000, v78
  v_lshlrev_b32 v22, 16, v75
  v_and_b32 v23, 0xffff0000, v75
  v_lshlrev_b32 v30, 16, v79
  v_and_b32 v31, 0xffff0000, v79
  s_cmp_eq_u32 s46, 0
  s_cbranch_scc1 L_pk0_74
  v_add_u32 v14, 123904, v6
  v_mul_f32 v10, v48, v16
  v_mul_f32 v12, v52, v16
  v_fma_f32 v10, -v52, v24, v10
  v_fma_f32 v12, v48, v24, v12
  v_mul_f32 v11, v49, v17
  v_mul_f32 v13, v53, v17
  v_fma_f32 v11, -v53, v25, v11
  v_fma_f32 v13, v49, v25, v13
  v_cvt_pk_bf16_f32 v80, v10, v11
  v_cvt_pk_bf16_f32 v82, v12, v13
  v_mul_f32 v10, v50, v18
  v_mul_f32 v12, v54, v18
  v_fma_f32 v10, -v54, v26, v10
  v_fma_f32 v12, v50, v26, v12
  v_mul_f32 v11, v51, v19
  v_mul_f32 v13, v55, v19
  v_fma_f32 v11, -v55, v27, v11
  v_fma_f32 v13, v51, v27, v13
  v_cvt_pk_bf16_f32 v81, v10, v11
  v_cvt_pk_bf16_f32 v83, v12, v13
  ds_write_b64 v14, v[80:81] offset:0
  ds_write_b64 v14, v[82:83] offset:4608
  v_mul_f32 v10, v56, v20
  v_mul_f32 v12, v60, v20
  v_fma_f32 v10, -v60, v28, v10
  v_fma_f32 v12, v56, v28, v12
  v_mul_f32 v11, v57, v21
  v_mul_f32 v13, v61, v21
  v_fma_f32 v11, -v61, v29, v11
  v_fma_f32 v13, v57, v29, v13
  v_cvt_pk_bf16_f32 v84, v10, v11
  v_cvt_pk_bf16_f32 v86, v12, v13
  v_mul_f32 v10, v58, v22
  v_mul_f32 v12, v62, v22
  v_fma_f32 v10, -v62, v30, v10
  v_fma_f32 v12, v58, v30, v12
  v_mul_f32 v11, v59, v23
  v_mul_f32 v13, v63, v23
  v_fma_f32 v11, -v63, v31, v11
  v_fma_f32 v13, v59, v31, v13
  v_cvt_pk_bf16_f32 v85, v10, v11
  v_cvt_pk_bf16_f32 v87, v12, v13
  ds_write_b64 v14, v[84:85] offset:2304
  ds_write_b64 v14, v[86:87] offset:6912
  s_branch L_pk0j_75
L_pk0_74:
  v_lshlrev_b32 v14, 2, v5
  v_lshl_add_u32 v14, v2, 11, v14
  v_lshl_add_u32 v14, v4, 9, v14
  v_add_u32 v15, 123904, v14
  s_mov_b32 s48, 0x05040100
  s_mov_b32 s49, 0x07060302
  s_waitcnt vmcnt(0)
  v_cvt_pk_bf16_f32 v32, v48, v52
  v_perm_b32 v33, v76, v72, s48
  v_perm_b32 v34, v84, v80, s48
  ds_write_b32 v15, v32 offset:15360
  ds_write_b32 v15, v33 offset:24576
  ds_write_b32 v15, v34 offset:0
  s_nop 0
  v_cvt_pk_bf16_f32 v32, v49, v53
  v_perm_b32 v33, v76, v72, s49
  v_perm_b32 v34, v84, v80, s49
  ds_write_b32 v15, v32 offset:15488
  ds_write_b32 v15, v33 offset:24704
  ds_write_b32 v15, v34 offset:128
  s_nop 0
  v_cvt_pk_bf16_f32 v32, v50, v54
  v_perm_b32 v33, v77, v73, s48
  v_perm_b32 v34, v85, v81, s48
  ds_write_b32 v15, v32 offset:15616
  ds_write_b32 v15, v33 offset:24832
  ds_write_b32 v15, v34 offset:256
  s_nop 0
  v_cvt_pk_bf16_f32 v32, v51, v55
  v_perm_b32 v33, v77, v73, s49
  v_perm_b32 v34, v85, v81, s49
  ds_write_b32 v15, v32 offset:15744
  ds_write_b32 v15, v33 offset:24960
  ds_write_b32 v15, v34 offset:384
  s_nop 0
  v_cvt_pk_bf16_f32 v32, v56, v60
  v_perm_b32 v33, v78, v74, s48
  v_perm_b32 v34, v86, v82, s48
  ds_write_b32 v15, v32 offset:15424
  ds_write_b32 v15, v33 offset:24640
  ds_write_b32 v15, v34 offset:64
  s_nop 0
  v_cvt_pk_bf16_f32 v32, v57, v61
  v_perm_b32 v33, v78, v74, s49
  v_perm_b32 v34, v86, v82, s49
  ds_write_b32 v15, v32 offset:15552
  ds_write_b32 v15, v33 offset:24768
  ds_write_b32 v15, v34 offset:192
  s_nop 0
  v_cvt_pk_bf16_f32 v32, v58, v62
  v_perm_b32 v33, v79, v75, s48
  v_perm_b32 v34, v87, v83, s48
  ds_write_b32 v15, v32 offset:15680
  ds_write_b32 v15, v33 offset:24896
  ds_write_b32 v15, v34 offset:320
  s_nop 0
  v_cvt_pk_bf16_f32 v32, v59, v63
  v_perm_b32 v33, v79, v75, s49
  v_perm_b32 v34, v87, v83, s49
  ds_write_b32 v15, v32 offset:15808
  ds_write_b32 v15, v33 offset:25024
  ds_write_b32 v15, v34 offset:448
  s_nop 0
  s_waitcnt lgkmcnt(0)
  s_mov_b64 exec, 1
  v_mov_b32 v12, 159992
  v_mov_b32 v13, 1
  ds_add_u32 v12, v13
  s_mov_b64 exec, -1
  s_setprio 0
  s_add_u32 s47, s47, 4
  v_mov_b32 v12, 159992
L_lw_76:
  ds_read_b32 v13, v12
  s_waitcnt lgkmcnt(0)
  v_readfirstlane_b32 s70, v13
  s_nop 0
  s_cmp_ge_u32 s70, s47
  s_cbranch_scc1 L_lwok_77
  s_add_u32 s71, s71, 1
  s_cmp_gt_u32 s71, 131072
  s_cbranch_scc1 L_lwok_77
  s_sleep 1
  s_branch L_lw_76
L_lwok_77:
  s_setprio 3
  v_sub_u32 v36, 8192, v14
  v_and_b32 v36, 8191, v36
  v_add_u32 v36, 123904, v36
  ds_read_b32 v64, v36 offset:15360
  ds_read_b32 v65, v36 offset:24576
  ds_read_b32 v66, v36
  v_sub_u32 v37, 8064, v14
  v_and_b32 v37, 8191, v37
  v_add_u32 v37, 123904, v37
  ds_read_b32 v67, v37 offset:15360
  ds_read_b32 v68, v37 offset:24576
  ds_read_b32 v69, v37
  v_sub_u32 v38, 7936, v14
  v_and_b32 v38, 8191, v38
  v_add_u32 v38, 123904, v38
  ds_read_b32 v70, v38 offset:15360
  ds_read_b32 v71, v38 offset:24576
  ds_read_b32 v32, v38
  v_sub_u32 v39, 7808, v14
  v_and_b32 v39, 8191, v39
  v_add_u32 v39, 123904, v39
  ds_read_b32 v33, v39 offset:15360
  ds_read_b32 v34, v39 offset:24576
  ds_read_b32 v35, v39
  s_waitcnt lgkmcnt(0)
  v_lshlrev_b32 v40, 16, v80
  v_lshlrev_b32 v41, 16, v84
  v_lshlrev_b32 v42, 16, v64
  v_and_b32 v43, 0xffff0000, v64
  v_lshlrev_b32 v44, 16, v65
  v_and_b32 v45, 0xffff0000, v65
  v_lshlrev_b32 v46, 16, v66
  v_and_b32 v47, 0xffff0000, v66
  v_add_f32 v44, v16, v44
  v_sub_f32 v45, v24, v45
  v_add_f32 v46, v40, v46
  v_sub_f32 v47, v41, v47
  v_add_f32 v64, v44, v46
  v_add_f32 v65, v45, v47
  v_sub_f32 v66, v44, v46
  v_sub_f32 v40, v45, v47
  v_mul_f32 v44, v64, v48
  v_mul_f32 v45, v64, v52
  v_fma_f32 v44, -v65, v52, v44
  v_fma_f32 v45, v65, v48, v45
  v_fma_f32 v44, v66, v42, v44
  v_fma_f32 v45, v40, v42, v45
  v_fma_f32 v44, v40, v43, v44
  v_fma_f32 v45, -v66, v43, v45
  v_mul_f32 v48, 0x3e000000, v44
  v_mul_f32 v52, 0x3e000000, v45
  v_and_b32 v40, 0xffff0000, v80
  v_and_b32 v41, 0xffff0000, v84
  v_lshlrev_b32 v42, 16, v67
  v_and_b32 v43, 0xffff0000, v67
  v_lshlrev_b32 v44, 16, v68
  v_and_b32 v45, 0xffff0000, v68
  v_lshlrev_b32 v46, 16, v69
  v_and_b32 v47, 0xffff0000, v69
  v_add_f32 v44, v17, v44
  v_sub_f32 v45, v25, v45
  v_add_f32 v46, v40, v46
  v_sub_f32 v47, v41, v47
  v_add_f32 v67, v44, v46
  v_add_f32 v68, v45, v47
  v_sub_f32 v69, v44, v46
  v_sub_f32 v40, v45, v47
  v_mul_f32 v44, v67, v49
  v_mul_f32 v45, v67, v53
  v_fma_f32 v44, -v68, v53, v44
  v_fma_f32 v45, v68, v49, v45
  v_fma_f32 v44, v69, v42, v44
  v_fma_f32 v45, v40, v42, v45
  v_fma_f32 v44, v40, v43, v44
  v_fma_f32 v45, -v69, v43, v45
  v_mul_f32 v49, 0x3e000000, v44
  v_mul_f32 v53, 0x3e000000, v45
  v_lshlrev_b32 v40, 16, v81
  v_lshlrev_b32 v41, 16, v85
  v_lshlrev_b32 v42, 16, v70
  v_and_b32 v43, 0xffff0000, v70
  v_lshlrev_b32 v44, 16, v71
  v_and_b32 v45, 0xffff0000, v71
  v_lshlrev_b32 v46, 16, v32
  v_and_b32 v47, 0xffff0000, v32
  v_add_f32 v44, v18, v44
  v_sub_f32 v45, v26, v45
  v_add_f32 v46, v40, v46
  v_sub_f32 v47, v41, v47
  v_add_f32 v70, v44, v46
  v_add_f32 v71, v45, v47
  v_sub_f32 v32, v44, v46
  v_sub_f32 v40, v45, v47
  v_mul_f32 v44, v70, v50
  v_mul_f32 v45, v70, v54
  v_fma_f32 v44, -v71, v54, v44
  v_fma_f32 v45, v71, v50, v45
  v_fma_f32 v44, v32, v42, v44
  v_fma_f32 v45, v40, v42, v45
  v_fma_f32 v44, v40, v43, v44
  v_fma_f32 v45, -v32, v43, v45
  v_mul_f32 v50, 0x3e000000, v44
  v_mul_f32 v54, 0x3e000000, v45
  v_and_b32 v40, 0xffff0000, v81
  v_and_b32 v41, 0xffff0000, v85
  v_lshlrev_b32 v42, 16, v33
  v_and_b32 v43, 0xffff0000, v33
  v_lshlrev_b32 v44, 16, v34
  v_and_b32 v45, 0xffff0000, v34
  v_lshlrev_b32 v46, 16, v35
  v_and_b32 v47, 0xffff0000, v35
  v_add_f32 v44, v19, v44
  v_sub_f32 v45, v27, v45
  v_add_f32 v46, v40, v46
  v_sub_f32 v47, v41, v47
  v_add_f32 v33, v44, v46
  v_add_f32 v34, v45, v47
  v_sub_f32 v35, v44, v46
  v_sub_f32 v40, v45, v47
  v_mul_f32 v44, v33, v51
  v_mul_f32 v45, v33, v55
  v_fma_f32 v44, -v34, v55, v44
  v_fma_f32 v45, v34, v51, v45
  v_fma_f32 v44, v35, v42, v44
  v_fma_f32 v45, v40, v42, v45
  v_fma_f32 v44, v40, v43, v44
  v_fma_f32 v45, -v35, v43, v45
  v_mul_f32 v51, 0x3e000000, v44
  v_mul_f32 v55, 0x3e000000, v45
  v_sub_u32 v36, 8128, v14
  v_and_b32 v36, 8191, v36
  v_add_u32 v36, 123904, v36
  ds_read_b32 v64, v36 offset:15360
  ds_read_b32 v65, v36 offset:24576
  ds_read_b32 v66, v36
  v_sub_u32 v37, 8000, v14
  v_and_b32 v37, 8191, v37
  v_add_u32 v37, 123904, v37
  ds_read_b32 v67, v37 offset:15360
  ds_read_b32 v68, v37 offset:24576
  ds_read_b32 v69, v37
  v_sub_u32 v38, 7872, v14
  v_and_b32 v38, 8191, v38
  v_add_u32 v38, 123904, v38
  ds_read_b32 v70, v38 offset:15360
  ds_read_b32 v71, v38 offset:24576
  ds_read_b32 v32, v38
  v_sub_u32 v39, 7744, v14
  v_and_b32 v39, 8191, v39
  v_add_u32 v39, 123904, v39
  ds_read_b32 v33, v39 offset:15360
  ds_read_b32 v34, v39 offset:24576
  ds_read_b32 v35, v39
  s_waitcnt lgkmcnt(0)
  v_lshlrev_b32 v40, 16, v82
  v_lshlrev_b32 v41, 16, v86
  v_lshlrev_b32 v42, 16, v64
  v_and_b32 v43, 0xffff0000, v64
  v_lshlrev_b32 v44, 16, v65
  v_and_b32 v45, 0xffff0000, v65
  v_lshlrev_b32 v46, 16, v66
  v_and_b32 v47, 0xffff0000, v66
  v_add_f32 v44, v20, v44
  v_sub_f32 v45, v28, v45
  v_add_f32 v46, v40, v46
  v_sub_f32 v47, v41, v47
  v_add_f32 v64, v44, v46
  v_add_f32 v65, v45, v47
  v_sub_f32 v66, v44, v46
  v_sub_f32 v40, v45, v47
  v_mul_f32 v44, v64, v56
  v_mul_f32 v45, v64, v60
  v_fma_f32 v44, -v65, v60, v44
  v_fma_f32 v45, v65, v56, v45
  v_fma_f32 v44, v66, v42, v44
  v_fma_f32 v45, v40, v42, v45
  v_fma_f32 v44, v40, v43, v44
  v_fma_f32 v45, -v66, v43, v45
  v_mul_f32 v56, 0x3e000000, v44
  v_mul_f32 v60, 0x3e000000, v45
  v_and_b32 v40, 0xffff0000, v82
  v_and_b32 v41, 0xffff0000, v86
  v_lshlrev_b32 v42, 16, v67
  v_and_b32 v43, 0xffff0000, v67
  v_lshlrev_b32 v44, 16, v68
  v_and_b32 v45, 0xffff0000, v68
  v_lshlrev_b32 v46, 16, v69
  v_and_b32 v47, 0xffff0000, v69
  v_add_f32 v44, v21, v44
  v_sub_f32 v45, v29, v45
  v_add_f32 v46, v40, v46
  v_sub_f32 v47, v41, v47
  v_add_f32 v67, v44, v46
  v_add_f32 v68, v45, v47
  v_sub_f32 v69, v44, v46
  v_sub_f32 v40, v45, v47
  v_mul_f32 v44, v67, v57
  v_mul_f32 v45, v67, v61
  v_fma_f32 v44, -v68, v61, v44
  v_fma_f32 v45, v68, v57, v45
  v_fma_f32 v44, v69, v42, v44
  v_fma_f32 v45, v40, v42, v45
  v_fma_f32 v44, v40, v43, v44
  v_fma_f32 v45, -v69, v43, v45
  v_mul_f32 v57, 0x3e000000, v44
  v_mul_f32 v61, 0x3e000000, v45
  v_lshlrev_b32 v40, 16, v83
  v_lshlrev_b32 v41, 16, v87
  v_lshlrev_b32 v42, 16, v70
  v_and_b32 v43, 0xffff0000, v70
  v_lshlrev_b32 v44, 16, v71
  v_and_b32 v45, 0xffff0000, v71
  v_lshlrev_b32 v46, 16, v32
  v_and_b32 v47, 0xffff0000, v32
  v_add_f32 v44, v22, v44
  v_sub_f32 v45, v30, v45
  v_add_f32 v46, v40, v46
  v_sub_f32 v47, v41, v47
  v_add_f32 v70, v44, v46
  v_add_f32 v71, v45, v47
  v_sub_f32 v32, v44, v46
  v_sub_f32 v40, v45, v47
  v_mul_f32 v44, v70, v58
  v_mul_f32 v45, v70, v62
  v_fma_f32 v44, -v71, v62, v44
  v_fma_f32 v45, v71, v58, v45
  v_fma_f32 v44, v32, v42, v44
  v_fma_f32 v45, v40, v42, v45
  v_fma_f32 v44, v40, v43, v44
  v_fma_f32 v45, -v32, v43, v45
  v_mul_f32 v58, 0x3e000000, v44
  v_mul_f32 v62, 0x3e000000, v45
  v_and_b32 v40, 0xffff0000, v83
  v_and_b32 v41, 0xffff0000, v87
  v_lshlrev_b32 v42, 16, v33
  v_and_b32 v43, 0xffff0000, v33
  v_lshlrev_b32 v44, 16, v34
  v_and_b32 v45, 0xffff0000, v34
  v_lshlrev_b32 v46, 16, v35
  v_and_b32 v47, 0xffff0000, v35
  v_add_f32 v44, v23, v44
  v_sub_f32 v45, v31, v45
  v_add_f32 v46, v40, v46
  v_sub_f32 v47, v41, v47
  v_add_f32 v33, v44, v46
  v_add_f32 v34, v45, v47
  v_sub_f32 v35, v44, v46
  v_sub_f32 v40, v45, v47
  v_mul_f32 v44, v33, v59
  v_mul_f32 v45, v33, v63
  v_fma_f32 v44, -v34, v63, v44
  v_fma_f32 v45, v34, v59, v45
  v_fma_f32 v44, v35, v42, v44
  v_fma_f32 v45, v40, v42, v45
  v_fma_f32 v44, v40, v43, v44
  v_fma_f32 v45, -v35, v43, v45
  v_mul_f32 v59, 0x3e000000, v44
  v_mul_f32 v63, 0x3e000000, v45
  s_waitcnt lgkmcnt(0)
  s_mov_b64 exec, 1
  v_mov_b32 v12, 159992
  v_mov_b32 v13, 1
  ds_add_u32 v12, v13
  s_mov_b64 exec, -1
  s_setprio 0
  s_add_u32 s47, s47, 4
  v_mov_b32 v12, 159992
L_lw_78:
  ds_read_b32 v13, v12
  s_waitcnt lgkmcnt(0)
  v_readfirstlane_b32 s70, v13
  s_nop 0
  s_cmp_ge_u32 s70, s47
  s_cbranch_scc1 L_lwok_79
  s_add_u32 s71, s71, 1
  s_cmp_gt_u32 s71, 131072
  s_cbranch_scc1 L_lwok_79
  s_sleep 1
  s_branch L_lw_78
L_lwok_79:
  s_setprio 3
  v_add_u32 v14, 123904, v6
  v_cvt_pk_bf16_f32 v80, v48, v49
  v_cvt_pk_bf16_f32 v82, v52, v53
  v_cvt_pk_bf16_f32 v81, v50, v51
  v_cvt_pk_bf16_f32 v83, v54, v55
  ds_write_b64 v14, v[80:81] offset:0
  ds_write_b64 v14, v[82:83] offset:4608
  v_cvt_pk_bf16_f32 v84, v56, v57
  v_cvt_pk_bf16_f32 v86, v60, v61
  v_cvt_pk_bf16_f32 v85, v58, v59
  v_cvt_pk_bf16_f32 v87, v62, v63
  ds_write_b64 v14, v[84:85] offset:2304
  ds_write_b64 v14, v[86:87] offset:6912
L_pk0j_75:
  s_waitcnt lgkmcnt(0)
  s_mov_b64 exec, 1
  v_mov_b32 v12, 159992
  v_mov_b32 v13, 1
  ds_add_u32 v12, v13
  s_mov_b64 exec, -1
  s_setprio 0
  s_add_u32 s47, s47, 4
  v_mov_b32 v12, 159992
L_lw_80:
  ds_read_b32 v13, v12
  s_waitcnt lgkmcnt(0)
  v_readfirstlane_b32 s70, v13
  s_nop 0
  s_cmp_ge_u32 s70, s47
  s_cbranch_scc1 L_lwok_81
  s_add_u32 s71, s71, 1
  s_cmp_gt_u32 s71, 131072
  s_cbranch_scc1 L_lwok_81
  s_sleep 1
  s_branch L_lw_80
L_lwok_81:
  s_setprio 3
  v_add_u32 v15, 123904, v7
  ds_read_b128 v[16:19], v15 offset:0
  ds_read_b128 v[32:35], v15 offset:4608
  ds_read_b128 v[20:23], v15 offset:64
  ds_read_b128 v[36:39], v15 offset:4672
  ds_read_b128 v[24:27], v15 offset:2304
  ds_read_b128 v[40:43], v15 offset:6912
  ds_read_b128 v[28:31], v15 offset:2368
  ds_read_b128 v[44:47], v15 offset:6976
  s_waitcnt lgkmcnt(0)
  v_mfma_f32_16x16x32_bf16 v[48:51], v[16:19], v[112:115], 0
  v_mfma_f32_16x16x32_bf16 v[52:55], v[32:35], v[112:115], 0
  v_mfma_f32_16x16x32_bf16 v[56:59], v[24:27], v[112:115], 0
  v_mfma_f32_16x16x32_bf16 v[60:63], v[40:43], v[112:115], 0
  v_mfma_f32_16x16x32_bf16 v[48:51], v[32:35], v[120:123], v[48:51]
  v_mfma_f32_16x16x32_bf16 v[52:55], v[16:19], v[116:119], v[52:55]
  v_mfma_f32_16x16x32_bf16 v[56:59], v[40:43], v[120:123], v[56:59]
  v_mfma_f32_16x16x32_bf16 v[60:63], v[24:27], v[116:119], v[60:63]
  v_mfma_f32_16x16x32_bf16 v[48:51], v[20:23], v[124:127], v[48:51]
  v_mfma_f32_16x16x32_bf16 v[52:55], v[36:39], v[124:127], v[52:55]
  v_mfma_f32_16x16x32_bf16 v[56:59], v[28:31], v[124:127], v[56:59]
  v_mfma_f32_16x16x32_bf16 v[60:63], v[44:47], v[124:127], v[60:63]
  v_mfma_f32_16x16x32_bf16 v[48:51], v[36:39], v[132:135], v[48:51]
  v_mfma_f32_16x16x32_bf16 v[52:55], v[20:23], v[128:131], v[52:55]
  v_mfma_f32_16x16x32_bf16 v[56:59], v[44:47], v[132:135], v[56:59]
  v_mfma_f32_16x16x32_bf16 v[60:63], v[28:31], v[128:131], v[60:63]
  s_nop 4
  v_mul_f32 v10, v48, v152
  v_mul_f32 v12, v52, v152
  v_fma_f32 v10, -v52, v160, v10
  v_fma_f32 v12, v48, v160, v12
  v_mul_f32 v11, v49, v153
  v_mul_f32 v13, v53, v153
  v_fma_f32 v11, -v53, v161, v11
  v_fma_f32 v13, v49, v161, v13
  v_cvt_pk_bf16_f32 v64, v10, v11
  v_cvt_pk_bf16_f32 v68, v12, v13
  v_mul_f32 v10, v50, v154
  v_mul_f32 v12, v54, v154
  v_fma_f32 v10, -v54, v162, v10
  v_fma_f32 v12, v50, v162, v12
  v_mul_f32 v11, v51, v155
  v_mul_f32 v13, v55, v155
  v_fma_f32 v11, -v55, v163, v11
  v_fma_f32 v13, v51, v163, v13
  v_cvt_pk_bf16_f32 v65, v10, v11
  v_cvt_pk_bf16_f32 v69, v12, v13
  v_mul_f32 v10, v56, v156
  v_mul_f32 v12, v60, v156
  v_fma_f32 v10, -v60, v164, v10
  v_fma_f32 v12, v56, v164, v12
  v_mul_f32 v11, v57, v157
  v_mul_f32 v13, v61, v157
  v_fma_f32 v11, -v61, v165, v11
  v_fma_f32 v13, v57, v165, v13
  v_cvt_pk_bf16_f32 v66, v10, v11
  v_cvt_pk_bf16_f32 v70, v12, v13
  v_mul_f32 v10, v58, v158
  v_mul_f32 v12, v62, v158
  v_fma_f32 v10, -v62, v166, v10
  v_fma_f32 v12, v58, v166, v12
  v_mul_f32 v11, v59, v159
  v_mul_f32 v13, v63, v159
  v_fma_f32 v11, -v63, v167, v11
  v_fma_f32 v13, v59, v167, v13
  v_cvt_pk_bf16_f32 v67, v10, v11
  v_cvt_pk_bf16_f32 v71, v12, v13
  s_nop 0
  v_mfma_f32_16x16x32_bf16 v[48:51], v[88:91], v[64:67], 0
  v_mfma_f32_16x16x32_bf16 v[52:55], v[88:91], v[68:71], 0
  v_mfma_f32_16x16x32_bf16 v[56:59], v[100:103], v[64:67], 0
  v_mfma_f32_16x16x32_bf16 v[60:63], v[100:103], v[68:71], 0
  v_mfma_f32_16x16x32_bf16 v[48:51], v[96:99], v[68:71], v[48:51]
  v_mfma_f32_16x16x32_bf16 v[52:55], v[92:95], v[64:67], v[52:55]
  v_mfma_f32_16x16x32_bf16 v[56:59], v[108:111], v[68:71], v[56:59]
  v_mfma_f32_16x16x32_bf16 v[60:63], v[104:107], v[64:67], v[60:63]
  s_nop 4
  v_cvt_pk_bf16_f32 v80, v48, v49
  v_cvt_pk_bf16_f32 v81, v50, v51
  v_cvt_pk_bf16_f32 v82, v56, v57
  v_cvt_pk_bf16_f32 v83, v58, v59
  v_cvt_pk_bf16_f32 v84, v52, v53
  v_cvt_pk_bf16_f32 v85, v54, v55
  v_cvt_pk_bf16_f32 v86, v60, v61
  v_cvt_pk_bf16_f32 v87, v62, v63
  s_setprio 0
  buffer_store_dwordx4 v[80:83], v8, s[20:23], s52 offen sc1
  s_waitcnt vmcnt(0)
  buffer_store_dwordx4 v[84:87], v8, s[20:23], s52 offen offset:16 sc1
  s_waitcnt vmcnt(0)
  s_mov_b64 exec, 1
  v_mov_b32 v10, 159944
  v_mov_b32 v11, 1
  ds_add_rtn_u32 v11, v10, v11
  s_waitcnt lgkmcnt(0)
  v_readfirstlane_b32 s70, v11
  s_nop 0
  s_and_b32 s70, s70, 3
  s_cmp_lg_u32 s70, 3
  s_cbranch_scc1 L_arr_82
  s_and_b32 s70, s2, 7
  s_cmp_eq_u32 s70, 0
  s_cselect_b32 s69, 32, 32
  s_lshl_b32 s70, s70, 7
  s_add_u32 s70, s70, 17572864
  v_mov_b32 v12, 0
  v_mov_b32 v13, 1
  s_mov_b64 exec, 1
  buffer_atomic_add v13, v12, s[20:23], s70 offen sc0 sc1
  s_waitcnt vmcnt(0)
  v_readfirstlane_b32 s70, v13
  s_nop 0
  s_add_u32 s70, s70, 1
  s_cmp_lg_u32 s70, s69
  s_cbranch_scc1 L_tree_83
  s_mov_b32 s70, 17575040
  v_mov_b32 v13, 1
  buffer_atomic_add v13, v12, s[20:23], s70 offen sc0 sc1
  s_waitcnt vmcnt(0)
  v_readfirstlane_b32 s70, v13
  s_nop 0
  s_cmp_lg_u32 s70, 7
  s_cbranch_scc1 L_tree_83
  s_mov_b64 exec, 0xff
  v_lshlrev_b32 v12, 7, v3
  v_mov_b32 v13, s42
  s_mov_b32 s70, 17576960
  buffer_store_dword v13, v12, s[20:23], s70 offen sc1
L_tree_83:
  s_mov_b64 exec, -1
  s_mov_b64 exec, 1
L_arr_82:
  s_mov_b64 exec, -1
  s_cmp_lg_u32 s40, 8
  s_cbranch_scc1 L_ow_84
  s_and_b32 s69, s2, 7
  s_lshl_b32 s69, s69, 7
  s_add_u32 s69, s69, 17576960
  v_mov_b32 v4, 0
L_pg_86:
  buffer_load_dword v5, v4, s[20:23], s69 offen sc1
  s_waitcnt vmcnt(0)
  v_readfirstlane_b32 s70, v5
  s_nop 0
  s_cmp_eq_u32 s70, s42
  s_cbranch_scc1 L_pgok_87
  s_add_u32 s71, s71, 1
  s_cmp_gt_u32 s71, 131072
  s_cbranch_scc1 L_pgok_87
  s_sleep 8
  s_branch L_pg_86
L_pgok_87:
  s_mov_b64 exec, 1
  v_mov_b32 v4, 159980
  v_mov_b32 v5, 1
  ds_write_b32 v4, v5
  s_mov_b64 exec, -1
  s_branch L_owd_85
L_ow_84:
  v_mov_b32 v4, 159980
L_lw_88:
  ds_read_b32 v5, v4
  s_waitcnt lgkmcnt(0)
  v_readfirstlane_b32 s70, v5
  s_nop 0
  s_cmp_ge_u32 s70, 1
  s_cbranch_scc1 L_lwok_89
  s_add_u32 s71, s71, 1
  s_cmp_gt_u32 s71, 131072
  s_cbranch_scc1 L_lwok_89
  s_sleep 8
  s_branch L_lw_88
L_lwok_89:
L_owd_85:
  s_mul_i32 s48, s2, 8320
  s_add_u32 s48, s48, 14680064
  s_lshl_b32 s49, s41, 11
  s_add_u32 s50, s48, s49
  s_add_u32 m0, s49, 148480
  s_add_u32 s51, s50, 1024
  buffer_load_dwordx4 v1, s[20:23], s50 offen sc1 lds
  s_add_u32 m0, s49, 149504
  s_nop 0
  buffer_load_dwordx4 v1, s[20:23], s51 offen sc1 lds
  v_mov_b32 v8, 160004
L_lw_90:
  ds_read_b32 v9, v8
  s_waitcnt lgkmcnt(0)
  v_readfirstlane_b32 s70, v9
  s_nop 0
  s_cmp_ge_u32 s70, 8
  s_cbranch_scc1 L_lwok_91
  s_add_u32 s71, s71, 1
  s_cmp_gt_u32 s71, 131072
  s_cbranch_scc1 L_lwok_91
  s_sleep 16
  s_branch L_lw_90
L_lwok_91:
  v_and_b32 v8, 15, v3
  v_cvt_f32_u32 v8, v8
  v_lshrrev_b32 v9, 5, v3
  v_cvt_f32_u32 v9, v9
  v_and_b32 v10, 31, v3
  v_cvt_f32_u32 v10, v10
  v_bfe_u32 v11, v3, 4, 1
  v_cmp_eq_u32 vcc, 0, v11
  s_nop 1
  v_cndmask_b32 v20, 0, -1, vcc
  v_not_b32 v21, v20
  v_mul_f32 v18, 0x3d800000, v8
  v_mul_f32 v19, 4.0, v9
  v_mul_f32 v19, v19, v18
  v_mov_b32 v12, 0x0
  v_fma_f32 v12, v18, v12, v19
  v_cos_f32 v13, v12
  v_sin_f32 v14, v12
  v_mul_f32 v13, 0x36000000, v13
  v_mul_f32 v14, 0x36000000, v14
  v_cvt_pk_bf16_f32 v15, v13, -v14
  v_cvt_pk_bf16_f32 v16, v14, v13
  v_and_b32 v32, v15, v20
  v_and_b32 v36, v15, v21
  v_and_b32 v40, v16, v20
  v_and_b32 v44, v16, v21
  v_mov_b32 v12, 0x3f800000
  v_fma_f32 v12, v18, v12, v19
  v_cos_f32 v13, v12
  v_sin_f32 v14, v12
  v_mul_f32 v13, 0x36000000, v13
  v_mul_f32 v14, 0x36000000, v14
  v_cvt_pk_bf16_f32 v15, v13, -v14
  v_cvt_pk_bf16_f32 v16, v14, v13
  v_and_b32 v33, v15, v20
  v_and_b32 v37, v15, v21
  v_and_b32 v41, v16, v20
  v_and_b32 v45, v16, v21
  v_mov_b32 v12, 0x40000000
  v_fma_f32 v12, v18, v12, v19
  v_cos_f32 v13, v12
  v_sin_f32 v14, v12
  v_mul_f32 v13, 0x36000000, v13
  v_mul_f32 v14, 0x36000000, v14
  v_cvt_pk_bf16_f32 v15, v13, -v14
  v_cvt_pk_bf16_f32 v16, v14, v13
  v_and_b32 v34, v15, v20
  v_and_b32 v38, v15, v21
  v_and_b32 v42, v16, v20
  v_and_b32 v46, v16, v21
  v_mov_b32 v12, 0x40400000
  v_fma_f32 v12, v18, v12, v19
  v_cos_f32 v13, v12
  v_sin_f32 v14, v12
  v_mul_f32 v13, 0x36000000, v13
  v_mul_f32 v14, 0x36000000, v14
  v_cvt_pk_bf16_f32 v15, v13, -v14
  v_cvt_pk_bf16_f32 v16, v14, v13
  v_and_b32 v35, v15, v20
  v_and_b32 v39, v15, v21
  v_and_b32 v43, v16, v20
  v_and_b32 v47, v16, v21
  v_mul_f32 v18, 0x3d000000, v10
  v_mul_f32 v19, 4.0, v9
  v_mul_f32 v22, v19, v18
  v_mov_b32 v12, 0x0
  v_fma_f32 v12, v18, v12, v22
  v_cos_f32 v14, v12
  v_sin_f32 v16, v12
  v_mov_b32 v13, 0x3f800000
  v_fma_f32 v13, v18, v13, v22
  v_cos_f32 v15, v13
  v_sin_f32 v17, v13
  v_cvt_pk_bf16_f32 v48, v14, v15
  v_cvt_pk_bf16_f32 v56, -v16, -v17
  v_mov_b32 v12, 0x40000000
  v_fma_f32 v12, v18, v12, v22
  v_cos_f32 v14, v12
  v_sin_f32 v16, v12
  v_mov_b32 v13, 0x40400000
  v_fma_f32 v13, v18, v13, v22
  v_cos_f32 v15, v13
  v_sin_f32 v17, v13
  v_cvt_pk_bf16_f32 v49, v14, v15
  v_cvt_pk_bf16_f32 v57, -v16, -v17
  v_mov_b32 v12, 0x41000000
  v_fma_f32 v12, v18, v12, v22
  v_cos_f32 v14, v12
  v_sin_f32 v16, v12
  v_mov_b32 v13, 0x41100000
  v_fma_f32 v13, v18, v13, v22
  v_cos_f32 v15, v13
  v_sin_f32 v17, v13
  v_cvt_pk_bf16_f32 v50, v14, v15
  v_cvt_pk_bf16_f32 v58, -v16, -v17
  v_mov_b32 v12, 0x41200000
  v_fma_f32 v12, v18, v12, v22
  v_cos_f32 v14, v12
  v_sin_f32 v16, v12
  v_mov_b32 v13, 0x41300000
  v_fma_f32 v13, v18, v13, v22
  v_cos_f32 v15, v13
  v_sin_f32 v17, v13
  v_cvt_pk_bf16_f32 v51, v14, v15
  v_cvt_pk_bf16_f32 v59, -v16, -v17
  v_mov_b32 v12, 0x41800000
  v_fma_f32 v12, v18, v12, v22
  v_cos_f32 v14, v12
  v_sin_f32 v16, v12
  v_mov_b32 v13, 0x41880000
  v_fma_f32 v13, v18, v13, v22
  v_cos_f32 v15, v13
  v_sin_f32 v17, v13
  v_cvt_pk_bf16_f32 v52, v14, v15
  v_cvt_pk_bf16_f32 v60, -v16, -v17
  v_mov_b32 v12, 0x41900000
  v_fma_f32 v12, v18, v12, v22
  v_cos_f32 v14, v12
  v_sin_f32 v16, v12
  v_mov_b32 v13, 0x41980000
  v_fma_f32 v13, v18, v13, v22
  v_cos_f32 v15, v13
  v_sin_f32 v17, v13
  v_cvt_pk_bf16_f32 v53, v14, v15
  v_cvt_pk_bf16_f32 v61, -v16, -v17
  v_mov_b32 v12, 0x41c00000
  v_fma_f32 v12, v18, v12, v22
  v_cos_f32 v14, v12
  v_sin_f32 v16, v12
  v_mov_b32 v13, 0x41c80000
  v_fma_f32 v13, v18, v13, v22
  v_cos_f32 v15, v13
  v_sin_f32 v17, v13
  v_cvt_pk_bf16_f32 v54, v14, v15
  v_cvt_pk_bf16_f32 v62, -v16, -v17
  v_mov_b32 v12, 0x41d00000
  v_fma_f32 v12, v18, v12, v22
  v_cos_f32 v14, v12
  v_sin_f32 v16, v12
  v_mov_b32 v13, 0x41d80000
  v_fma_f32 v13, v18, v13, v22
  v_cos_f32 v15, v13
  v_sin_f32 v17, v13
  v_cvt_pk_bf16_f32 v55, v14, v15
  v_cvt_pk_bf16_f32 v63, -v16, -v17
  v_mul_f32 v18, 0x3b000000, v8
  v_mul_f32 v22, v19, v18
  v_mov_b32 v12, 0x0
  v_fma_f32 v12, v18, v12, v22
  v_cos_f32 v64, v12
  v_sin_f32 v80, v12
  v_mov_b32 v12, 0x3f800000
  v_fma_f32 v12, v18, v12, v22
  v_cos_f32 v65, v12
  v_sin_f32 v81, v12
  v_mov_b32 v12, 0x40000000
  v_fma_f32 v12, v18, v12, v22
  v_cos_f32 v66, v12
  v_sin_f32 v82, v12
  v_mov_b32 v12, 0x40400000
  v_fma_f32 v12, v18, v12, v22
  v_cos_f32 v67, v12
  v_sin_f32 v83, v12
  v_mov_b32 v12, 0x41000000
  v_fma_f32 v12, v18, v12, v22
  v_cos_f32 v68, v12
  v_sin_f32 v84, v12
  v_mov_b32 v12, 0x41100000
  v_fma_f32 v12, v18, v12, v22
  v_cos_f32 v69, v12
  v_sin_f32 v85, v12
  v_mov_b32 v12, 0x41200000
  v_fma_f32 v12, v18, v12, v22
  v_cos_f32 v70, v12
  v_sin_f32 v86, v12
  v_mov_b32 v12, 0x41300000
  v_fma_f32 v12, v18, v12, v22
  v_cos_f32 v71, v12
  v_sin_f32 v87, v12
  v_mov_b32 v12, 0x41800000
  v_fma_f32 v12, v18, v12, v22
  v_cos_f32 v72, v12
  v_sin_f32 v88, v12
  v_mov_b32 v12, 0x41880000
  v_fma_f32 v12, v18, v12, v22
  v_cos_f32 v73, v12
  v_sin_f32 v89, v12
  v_mov_b32 v12, 0x41900000
  v_fma_f32 v12, v18, v12, v22
  v_cos_f32 v74, v12
  v_sin_f32 v90, v12
  v_mov_b32 v12, 0x41980000
  v_fma_f32 v12, v18, v12, v22
  v_cos_f32 v75, v12
  v_sin_f32 v91, v12
  v_mov_b32 v12, 0x41c00000
  v_fma_f32 v12, v18, v12, v22
  v_cos_f32 v76, v12
  v_sin_f32 v92, v12
  v_mov_b32 v12, 0x41c80000
  v_fma_f32 v12, v18, v12, v22
  v_cos_f32 v77, v12
  v_sin_f32 v93, v12
  v_mov_b32 v12, 0x41d00000
  v_fma_f32 v12, v18, v12, v22
  v_cos_f32 v78, v12
  v_sin_f32 v94, v12
  v_mov_b32 v12, 0x41d80000
  v_fma_f32 v12, v18, v12, v22
  v_cos_f32 v79, v12
  v_sin_f32 v95, v12
  v_and_b32 v5, 31, v3
  v_lshlrev_b32 v5, 5, v5
  v_lshrrev_b32 v6, 5, v3
  v_lshl_add_u32 v5, v6, 12, v5
  v_lshl_add_u32 v5, v2, 2, v5
  v_add_u32 v5, 148480, v5
  v_lshlrev_b32 v6, 2, v2
  v_add_u32 v6, 148496, v6
  v_and_b32 v8, 1, v3
  v_lshlrev_b32 v8, 31, v8
  v_or_b32 v8, 0x36000000, v8
  v_cmp_gt_u32 vcc, 32, v3
  s_nop 1
  v_cndmask_b32 v7, 0, v8, vcc
  s_waitcnt vmcnt(0) lgkmcnt(0)
  s_mov_b64 exec, 1
  v_mov_b32 v12, 159952
  v_mov_b32 v13, 1
  ds_add_rtn_u32 v13, v12, v13
  s_waitcnt lgkmcnt(0)
  v_readfirstlane_b32 s70, v13
  s_nop 0
  s_cmp_lg_u32 s70, 3
  s_cbranch_scc1 L_arr_92
L_arr_92:
  s_mov_b64 exec, -1
  v_mov_b32 v12, 159952
L_lw_93:
  ds_read_b32 v13, v12
  s_waitcnt lgkmcnt(0)
  v_readfirstlane_b32 s70, v13
  s_nop 0
  s_cmp_ge_u32 s70, 4
  s_cbranch_scc1 L_lwok_94
  s_add_u32 s71, s71, 1
  s_cmp_gt_u32 s71, 131072
  s_cbranch_scc1 L_lwok_94
  s_branch L_lw_93
L_lwok_94:
  ds_read_b32 v24, v5 offset:0
  ds_read_b32 v25, v5 offset:16
  ds_read_b32 v26, v5 offset:1024
  ds_read_b32 v27, v5 offset:1040
  ds_read_b32 v28, v5 offset:2048
  ds_read_b32 v29, v5 offset:2064
  ds_read_b32 v30, v5 offset:3072
  ds_read_b32 v31, v5 offset:3088
  ds_read_b32 v9, v6
  s_mov_b32 s48, 0x05040100
  s_mov_b32 s49, 0x07060302
  s_waitcnt lgkmcnt(0)
  v_perm_b32 v16, v25, v24, s48
  v_perm_b32 v20, v25, v24, s49
  v_perm_b32 v17, v27, v26, s48
  v_perm_b32 v21, v27, v26, s49
  v_perm_b32 v18, v29, v28, s48
  v_perm_b32 v22, v29, v28, s49
  v_perm_b32 v19, v31, v30, s48
  v_perm_b32 v23, v31, v30, s49
  v_lshlrev_b32 v10, 16, v9
  v_and_b32 v9, 0xffff0000, v9
  v_bfe_u32 v8, v3, 4, 1
  v_cmp_eq_u32 vcc, 0, v8
  s_nop 1
  v_cndmask_b32 v9, v9, v10, vcc
  v_mfma_f32_32x32x16_bf16 v[96:111], v[16:19], v[32:35], 0
  v_mfma_f32_32x32x16_bf16 v[112:127], v[16:19], v[40:43], 0
  v_mfma_f32_32x32x16_bf16 v[96:111], v[20:23], v[36:39], v[96:111]
  v_mfma_f32_32x32x16_bf16 v[112:127], v[20:23], v[44:47], v[112:127]
  s_nop 10
  v_fma_f32 v96, v9, v7, v96
  v_pk_mul_f32 v[16:17], v[96:97], v[64:65]
  v_pk_mul_f32 v[18:19], v[112:113], v[64:65]
  v_pk_fma_f32 v[16:17], v[112:113], v[80:81], v[16:17] neg_lo:[0,1,0] neg_hi:[0,1,0]
  v_pk_fma_f32 v[18:19], v[96:97], v[80:81], v[18:19]
  v_cvt_pk_bf16_f32 v128, v16, v17
  v_cvt_pk_bf16_f32 v136, v18, v19
  v_pk_mul_f32 v[16:17], v[98:99], v[66:67]
  v_pk_mul_f32 v[18:19], v[114:115], v[66:67]
  v_pk_fma_f32 v[16:17], v[114:115], v[82:83], v[16:17] neg_lo:[0,1,0] neg_hi:[0,1,0]
  v_pk_fma_f32 v[18:19], v[98:99], v[82:83], v[18:19]
  v_cvt_pk_bf16_f32 v129, v16, v17
  v_cvt_pk_bf16_f32 v137, v18, v19
  v_pk_mul_f32 v[16:17], v[100:101], v[68:69]
  v_pk_mul_f32 v[18:19], v[116:117], v[68:69]
  v_pk_fma_f32 v[16:17], v[116:117], v[84:85], v[16:17] neg_lo:[0,1,0] neg_hi:[0,1,0]
  v_pk_fma_f32 v[18:19], v[100:101], v[84:85], v[18:19]
  v_cvt_pk_bf16_f32 v130, v16, v17
  v_cvt_pk_bf16_f32 v138, v18, v19
  v_pk_mul_f32 v[16:17], v[102:103], v[70:71]
  v_pk_mul_f32 v[18:19], v[118:119], v[70:71]
  v_pk_fma_f32 v[16:17], v[118:119], v[86:87], v[16:17] neg_lo:[0,1,0] neg_hi:[0,1,0]
  v_pk_fma_f32 v[18:19], v[102:103], v[86:87], v[18:19]
  v_cvt_pk_bf16_f32 v131, v16, v17
  v_cvt_pk_bf16_f32 v139, v18, v19
  v_pk_mul_f32 v[16:17], v[104:105], v[72:73]
  v_pk_mul_f32 v[18:19], v[120:121], v[72:73]
  v_pk_fma_f32 v[16:17], v[120:121], v[88:89], v[16:17] neg_lo:[0,1,0] neg_hi:[0,1,0]
  v_pk_fma_f32 v[18:19], v[104:105], v[88:89], v[18:19]
  v_cvt_pk_bf16_f32 v132, v16, v17
  v_cvt_pk_bf16_f32 v140, v18, v19
  v_pk_mul_f32 v[16:17], v[106:107], v[74:75]
  v_pk_mul_f32 v[18:19], v[122:123], v[74:75]
  v_pk_fma_f32 v[16:17], v[122:123], v[90:91], v[16:17] neg_lo:[0,1,0] neg_hi:[0,1,0]
  v_pk_fma_f32 v[18:19], v[106:107], v[90:91], v[18:19]
  v_cvt_pk_bf16_f32 v133, v16, v17
  v_cvt_pk_bf16_f32 v141, v18, v19
  v_pk_mul_f32 v[16:17], v[108:109], v[76:77]
  v_pk_mul_f32 v[18:19], v[124:125], v[76:77]
  v_pk_fma_f32 v[16:17], v[124:125], v[92:93], v[16:17] neg_lo:[0,1,0] neg_hi:[0,1,0]
  v_pk_fma_f32 v[18:19], v[108:109], v[92:93], v[18:19]
  v_cvt_pk_bf16_f32 v134, v16, v17
  v_cvt_pk_bf16_f32 v142, v18, v19
  v_pk_mul_f32 v[16:17], v[110:111], v[78:79]
  v_pk_mul_f32 v[18:19], v[126:127], v[78:79]
  v_pk_fma_f32 v[16:17], v[126:127], v[94:95], v[16:17] neg_lo:[0,1,0] neg_hi:[0,1,0]
  v_pk_fma_f32 v[18:19], v[110:111], v[94:95], v[18:19]
  v_cvt_pk_bf16_f32 v135, v16, v17
  v_cvt_pk_bf16_f32 v143, v18, v19
  v_mfma_f32_32x32x16_bf16 v[96:111], v[128:131], v[48:51], 0
  v_mfma_f32_32x32x16_bf16 v[96:111], v[132:135], v[52:55], v[96:111]
  v_mfma_f32_32x32x16_bf16 v[96:111], v[136:139], v[56:59], v[96:111]
  v_mfma_f32_32x32x16_bf16 v[96:111], v[140:143], v[60:63], v[96:111]
  v_and_b32 v7, 31, v3
  v_lshlrev_b32 v7, 5, v7
  v_lshrrev_b32 v8, 5, v3
  v_lshl_add_u32 v5, v8, 4, v7
  s_lshr_b32 s48, s2, 6
  s_lshl_b32 s48, s48, 2
  s_and_b32 s49, s41, 1
  s_lshl_b32 s49, s49, 1
  s_lshr_b32 s50, s41, 1
  s_lshl_b32 s50, s50, 4
  s_add_u32 s48, s48, s49
  s_add_u32 s48, s48, s50
  s_lshl_b32 s48, s48, 6
  s_and_b32 s49, s2, 63
  s_add_u32 s48, s48, s49
  s_lshl_b32 s48, s48, 11
  s_add_u32 s48, s48, 1024
  s_add_u32 s49, s48, 131072
  v_cvt_pk_bf16_f32 v128, v96, v97
  v_cvt_pk_bf16_f32 v129, v98, v99
  v_cvt_pk_bf16_f32 v130, v100, v101
  v_cvt_pk_bf16_f32 v131, v102, v103
  s_nop 0
  v_permlane32_swap_b32 v128, v130
  v_permlane32_swap_b32 v129, v131
  v_cvt_pk_bf16_f32 v132, v104, v105
  v_cvt_pk_bf16_f32 v133, v106, v107
  v_cvt_pk_bf16_f32 v134, v108, v109
  v_cvt_pk_bf16_f32 v135, v110, v111
  s_nop 0
  v_permlane32_swap_b32 v132, v134
  v_permlane32_swap_b32 v133, v135
  buffer_store_dwordx4 v[128:131], v5, s[32:35], s48 offen
  buffer_store_dwordx4 v[132:135], v5, s[32:35], s49 offen
  s_endpgm
L_att_fallback:
  s_nop 7
  s_nop 7
  s_add_u32 s66, s53, 2097152
  s_add_u32 s67, s53, 4194304
  v_mov_b32 v88, 0xff800000
  s_mov_b32 s64, 64
  s_mov_b32 s68, s66
L_fb_max:
  buffer_load_dwordx4 v[8:11], v1, s[20:23], s68 offen sc1
  s_waitcnt vmcnt(0)
  v_mfma_f32_32x32x16_bf16 v[32:47], v[8:11], v[4:7], 0
  s_nop 7
  s_nop 7
  v_max3_f32 v88, v88, v32, v33
  v_max3_f32 v88, v88, v34, v35
  v_max3_f32 v88, v88, v36, v37
  v_max3_f32 v88, v88, v38, v39
  v_max3_f32 v88, v88, v40, v41
  v_max3_f32 v88, v88, v42, v43
  v_max3_f32 v88, v88, v44, v45
  v_max3_f32 v88, v88, v46, v47
  s_add_u32 s68, s68, 1024
  s_sub_u32 s64, s64, 1
  s_cmp_lg_u32 s64, 0
  s_cbranch_scc1 L_fb_max
  v_mov_b32 v89, v88
  s_nop 1
  v_permlane32_swap_b32 v88, v89
  s_nop 1
  v_max_f32 v88, v88, v89
  v_sub_f32 v48, 0, v88
  v_sub_f32 v49, 0, v88
  v_sub_f32 v50, 0, v88
  v_sub_f32 v51, 0, v88
  v_sub_f32 v52, 0, v88
  v_sub_f32 v53, 0, v88
  v_sub_f32 v54, 0, v88
  v_sub_f32 v55, 0, v88
  v_sub_f32 v56, 0, v88
  v_sub_f32 v57, 0, v88
  v_sub_f32 v58, 0, v88
  v_sub_f32 v59, 0, v88
  v_sub_f32 v60, 0, v88
  v_sub_f32 v61, 0, v88
  v_sub_f32 v62, 0, v88
  v_sub_f32 v63, 0, v88
  v_mov_b32 v64, 0
  v_mov_b32 v65, 0
  v_mov_b32 v66, 0
  v_mov_b32 v67, 0
  v_mov_b32 v68, 0
  v_mov_b32 v69, 0
  v_mov_b32 v70, 0
  v_mov_b32 v71, 0
  v_mov_b32 v72, 0
  v_mov_b32 v73, 0
  v_mov_b32 v74, 0
  v_mov_b32 v75, 0
  v_mov_b32 v76, 0
  v_mov_b32 v77, 0
  v_mov_b32 v78, 0
  v_mov_b32 v79, 0
  v_and_b32 v88, 27, v3
  v_cmp_eq_u32 vcc, 16, v88
  v_mov_b32 v89, 0x3f803f80
  s_nop 1
  v_cndmask_b32 v88, 0, v89, vcc
  v_mov_b32 v16, v88
  v_mov_b32 v17, v88
  v_mov_b32 v18, v88
  v_mov_b32 v19, v88
  v_mov_b32 v20, v88
  v_mov_b32 v21, v88
  v_mov_b32 v22, v88
  v_mov_b32 v23, v88
  s_mov_b32 s64, 64
L_fb_pv:
  buffer_load_dwordx4 v[8:11], v1, s[20:23], s66 offen sc1
  s_mov_b64 exec, s[60:61]
  buffer_load_dwordx4 v[16:19], v94, s[20:23], s67 offen sc1
  buffer_load_dwordx4 v[20:23], v94, s[20:23], s67 offen offset:512 sc1
  s_mov_b64 exec, -1
  s_waitcnt vmcnt(0)
  s_nop 7
  v_mfma_f32_32x32x16_bf16 v[32:47], v[8:11], v[4:7], v[48:63]
  s_nop 7
  s_nop 7
  v_exp_f32 v32, v32
  v_exp_f32 v33, v33
  v_exp_f32 v34, v34
  v_exp_f32 v35, v35
  v_exp_f32 v36, v36
  v_exp_f32 v37, v37
  v_exp_f32 v38, v38
  v_exp_f32 v39, v39
  v_exp_f32 v40, v40
  v_exp_f32 v41, v41
  v_exp_f32 v42, v42
  v_exp_f32 v43, v43
  v_exp_f32 v44, v44
  v_exp_f32 v45, v45
  v_exp_f32 v46, v46
  v_exp_f32 v47, v47
  s_nop 1
  v_cvt_pk_bf16_f32 v80, v32, v33
  v_cvt_pk_bf16_f32 v81, v34, v35
  v_cvt_pk_bf16_f32 v82, v36, v37
  v_cvt_pk_bf16_f32 v83, v38, v39
  v_cvt_pk_bf16_f32 v84, v40, v41
  v_cvt_pk_bf16_f32 v85, v42, v43
  v_cvt_pk_bf16_f32 v86, v44, v45
  v_cvt_pk_bf16_f32 v87, v46, v47
  s_nop 1
  v_mfma_f32_32x32x16_bf16 v[64:79], v[16:19], v[80:83], v[64:79]
  v_mfma_f32_32x32x16_bf16 v[64:79], v[20:23], v[84:87], v[64:79]
  s_nop 7
  s_nop 7
  s_add_u32 s66, s66, 1024
  s_add_u32 s67, s67, 1024
  s_sub_u32 s64, s64, 1
  s_cmp_lg_u32 s64, 0
  s_cbranch_scc1 L_fb_pv
  s_nop 7
  s_nop 7
  s_branch L_att_fin
L_end:
  s_endpgm
L_code_end:

.section .rodata,"a"
.p2align 6
.amdhsa_kernel concat_heads__mha_block__spectral_gfnet__prompt_kernel
  .amdhsa_next_free_vgpr 168
  .amdhsa_next_free_sgpr 80
  .amdhsa_accum_offset 168
  .amdhsa_group_segment_fixed_size 0
  .amdhsa_kernarg_size 72
  .amdhsa_user_sgpr_count 2
  .amdhsa_user_sgpr_kernarg_segment_ptr 1
  .amdhsa_system_sgpr_workgroup_id_x 1
.end_amdhsa_kernel
```
